```python
import torch

def _softmax(x, axis=-1):
    return torch.softmax(x, dim=axis)

def _gelu(x):
    return torch.nn.functional.gelu(x, approximate='tanh')

def _silu(x):
    return torch.nn.functional.silu(x)

def _sigmoid(x):
    return torch.sigmoid(x)

def _layernorm(x, axis=-1, eps=1e-05):
    m = x.mean(dim=axis, keepdim=True)
    v = x.var(dim=axis, keepdim=True, unbiased=False)
    return (x - m) / torch.sqrt(v + eps)

def _scatter_add(tgt, idx, src, axis=0):
    return tgt.clone().index_add_(axis, idx, src)

def _segment_sum(src, seg, n):
    out = torch.zeros((n,) + src.shape[1:], dtype=src.dtype)
    return out.index_add_(0, seg, src)

def _pad(x, pw):
    flat = tuple((v for pair in reversed(pw) for v in pair))
    return torch.nn.functional.pad(x, flat)
kernel_name = 'adaLN_cond__sliding_block_cached__glu_gated_bilinear__decode'

def setup_inputs():

    _w = lambda a: (lambda t: t.to(torch.bfloat16) if t.is_floating_point() else t)(torch.as_tensor(a))

    def _A_setup():
        B, Sq, D = (1, 1, 640)
        Hq, Hkv, Sk, Dh = (32, 32, 32768, 192)
        assert Hq % Hkv == 0, (Hq, Hkv)
        return {'x': _w((lambda *s: torch.randn(*s, dtype=torch.bfloat16) * 0.05)(B, Sq, D)), 'k_cache': _w((lambda *s: torch.randn(*s, dtype=torch.bfloat16) * 3.2)(B, Hkv, Sk, Dh)), 'v_cache': _w((lambda *s: torch.randn(*s, dtype=torch.bfloat16) * 3.2)(B, Hkv, Sk, Dh)), 'wq': _w((lambda *s: torch.randn(*s, dtype=torch.bfloat16) * 3.2)(D, Hq * Dh) * D ** (-0.5)), 'wo': _w((lambda *s: torch.randn(*s, dtype=torch.bfloat16) * 3.2)(Hq * Dh, D) * (Hq * Dh) ** (-0.5))}
    _A_in = _A_setup()

    def _B_setup():
        B, S, D, F = (1, 1, 640, 1536)
        return {'x': _w((lambda *s: torch.randn(*s, dtype=torch.bfloat16) * 0.05)(B, S, D)), 'w_gate': _w((lambda *s: torch.randn(*s, dtype=torch.bfloat16) * 3.2)(D, F) * D ** (-0.5)), 'w_up': _w((lambda *s: torch.randn(*s, dtype=torch.bfloat16) * 3.2)(D, F) * D ** (-0.5)), 'w_down': _w((lambda *s: torch.randn(*s, dtype=torch.bfloat16) * 3.2)(F, D) * F ** (-0.5))}
    _B_in = _B_setup()
    return {'A_x': _A_in['x'], 'A_k_cache': _A_in['k_cache'], 'A_v_cache': _A_in['v_cache'], 'A_wq': _A_in['wq'], 'A_wo': _A_in['wo'], 'B_x': _B_in['x'], 'B_w_gate': _B_in['w_gate'], 'B_w_up': _B_in['w_up'], 'B_w_down': _B_in['w_down'], 'c': _w((lambda *s: torch.randn(*s, dtype=torch.bfloat16) * 0.2)(1, 640) * 8.0), 'w_mod': _w((lambda *s: torch.randn(*s, dtype=torch.bfloat16) * 0.2)(640, 6 * 640) * 640 ** (-0.5) * 8.0)}

def reference(A_x, A_k_cache, A_v_cache, A_wq, A_wo, B_x, B_w_gate, B_w_up, B_w_down, c, w_mod):

    def _A_ref(x, k_cache, v_cache, wq, wo):
        B, Sq, D = x.shape
        Hq, Dh = (32, 192)
        Hkv, Sk = (k_cache.shape[1], k_cache.shape[2])
        W = min(4096, max(256, Sk // 4))
        rep = Hq // Hkv
        q = (lambda x, *d: x.permute(*d))((x @ wq).reshape(B, Sq, Hq, Dh), 0, 2, 1, 3)
        k = (lambda x, n, axis: torch.repeat_interleave(x, n, dim=axis))(k_cache[:, :, Sk - W:, :], rep, axis=1)
        v = (lambda x, n, axis: torch.repeat_interleave(x, n, dim=axis))(v_cache[:, :, Sk - W:, :], rep, axis=1)
        scores = torch.einsum('bhqd,bhkd->bhqk', q, k) * Dh ** (-0.5)
        p = _softmax(scores, axis=-1)
        o = torch.einsum('bhqk,bhkd->bhqd', p, v)
        return (lambda x, *d: x.permute(*d))(o, 0, 2, 1, 3).reshape(B, Sq, Hq * Dh) @ wo

    def _B_ref(x, w_gate, w_up, w_down):
        g = torch.einsum('bsd,df->bsf', x, w_gate)
        u = torch.einsum('bsd,df->bsf', x, w_up)
        h = g * u
        return torch.einsum('bsf,fd->bsd', h, w_down)
    x = A_x
    mod = (_silu(c) @ w_mod).reshape(c.shape[0], 6, 1, -1)
    sa, ca, ga, sb, cb, gb = (mod[:, 0].clone(), mod[:, 1].clone(), mod[:, 2].clone(), mod[:, 3].clone(), mod[:, 4].clone(), mod[:, 5].clone())
    h = _layernorm(x, axis=-1) * (1 + ca) + sa
    x = x + ga * _A_ref(h, A_k_cache, A_v_cache, A_wq, A_wo)
    h = _layernorm(x, axis=-1) * (1 + cb) + sb
    x = x + gb * _B_ref(h, B_w_gate, B_w_up, B_w_down)
    return x
```

```asm
; @launch grid=(256,1,1) block=(768,1,1) lds=163840
.amdgcn_target "amdgcn-amd-amdhsa--gfx950"
.text
.globl adaLN_cond__sliding_block_cached__glu_gated_bilinear__decode_kernel
.p2align 8
.type adaLN_cond__sliding_block_cached__glu_gated_bilinear__decode_kernel,@function
adaLN_cond__sliding_block_cached__glu_gated_bilinear__decode_kernel:
  s_cmp_ge_u32 s2, 256
  s_cbranch_scc1 L_exit
  s_load_dwordx16 s[16:31], s[0:1], 0
  s_load_dwordx8 s[32:39], s[0:1], 64
  s_load_dwordx4 s[40:43], s[0:1], 96
  v_lshrrev_b32 v2, 6, v0
  v_and_b32 v1, 63, v0
  v_readfirstlane_b32 s3, v2
  s_mov_b32 s8, s2
  s_mov_b32 s4, s2
  s_lshr_b32 s5, s4, 3
  s_and_b32 s6, s4, 7
  s_mul_i32 s9, s2, 205
  s_lshr_b32 s9, s9, 11
  s_mul_i32 s10, s9, 10
  s_sub_u32 s10, s2, s10
  s_mov_b32 s7, 0
  s_waitcnt lgkmcnt(0)
  s_cmp_ge_u32 s3, 8
  s_cbranch_scc1 L_aux
L_bulk:
  s_lshl_b32 s70, s5, 15
  s_add_u32 s70, s70, 28672
  s_mul_i32 s70, s70, 384
  s_add_u32 s44, s18, s70
  s_addc_u32 s45, s19, 0
  s_and_b32 s45, s45, 0xffff
  s_mov_b32 s46, 1572864
  s_mov_b32 s47, 0x20000
  s_add_u32 s48, s20, s70
  s_addc_u32 s49, s21, 0
  s_and_b32 s49, s49, 0xffff
  s_mov_b32 s50, 1572864
  s_mov_b32 s51, 0x20000
  s_lshl_b32 s71, s6, 3
  s_add_u32 s71, s71, s3
  s_mul_i32 s72, s71, 21504
  s_add_u32 s73, s72, 3072
  s_add_u32 s74, s72, 6144
  s_add_u32 s75, s72, 9216
  s_add_u32 s76, s72, 12288
  s_add_u32 s77, s72, 15360
  s_add_u32 s78, s72, 18432
  v_lshrrev_b32 v161, 3, v1
  v_mul_u32_u24 v2, 384, v161
  v_and_b32 v144, 7, v1
  v_lshlrev_b32 v144, 4, v144
  v_add_u32 v2, v2, v144
  v_mov_b32 v3, 0
  v_mov_b32 v160, 1
  v_and_b32 v145, 8, v1
  v_cmp_ne_u32 s[68:69], 0, v145
  s_mov_b32 s64, s42
  s_and_b32 s65, s43, 0xffff
  s_mov_b32 s66, 1966080
  s_mov_b32 s67, 0x20000
  s_cmp_lt_u32 s8, 160
  s_cbranch_scc1 L_bs_wo
  s_cmp_lt_u32 s8, 208
  s_cbranch_scc1 L_bs_gu
  s_cmp_lt_u32 s8, 228
  s_cselect_b32 s71, 1966080, 0
  s_mov_b32 s52, s32
  s_and_b32 s53, s33, 0xffff
  s_mov_b32 s54, s71
  s_mov_b32 s55, 0x20000
  v_lshrrev_b32 v161, 2, v1
  v_mul_u32_u24 v161, 1280, v161
  v_and_b32 v145, 3, v1
  v_lshl_add_u32 v161, v145, 4, v161
  s_mul_i32 s80, s3, 245760
  s_sub_u32 s71, s8, 208
  s_lshl_b32 s71, s71, 6
  s_add_u32 s80, s80, s71
  s_mov_b32 s81, 20480
  s_mov_b32 s83, 20480
  s_branch L_bs_done
L_bs_gu:
  s_sub_u32 s84, s8, 160
  s_and_b32 s70, s84, 1
  s_cmp_eq_u32 s70, 0
  s_cselect_b32 s70, s28, s30
  s_cselect_b32 s71, s29, s31
  s_mov_b32 s52, s70
  s_and_b32 s53, s71, 0xffff
  s_mov_b32 s54, 1966080
  s_mov_b32 s55, 0x20000
  v_mul_u32_u24 v161, 3072, v161
  v_add_u32 v161, v161, v144
  s_mul_i32 s80, s3, 245760
  s_lshr_b32 s71, s84, 1
  s_lshl_b32 s71, s71, 7
  s_add_u32 s80, s80, s71
  s_mov_b32 s81, 24576
  s_mov_b32 s83, 24576
  s_branch L_bs_done
L_bs_wo:
  s_mov_b32 s52, s24
  s_and_b32 s53, s25, 0xffff
  s_mov_b32 s54, 7864320
  s_mov_b32 s55, 0x20000
  v_mul_u32_u24 v161, 3840, v161
  v_add_u32 v161, v161, v144
  s_mul_i32 s70, s9, 384
  s_mul_i32 s71, s3, 48
  s_add_u32 s84, s70, s71
  s_mul_i32 s80, s84, 1280
  s_lshl_b32 s71, s10, 7
  s_add_u32 s80, s80, s71
  s_mov_b32 s81, 1280
  s_mov_b32 s83, 28160
L_bs_done:
  v_lshlrev_b32 v162, 4, v1
  s_mul_i32 s71, s3, 18432
  s_add_u32 s71, s71, 16384
  s_mov_b32 m0, s71
  v_add_u32 v163, s71, v2
  s_mov_b32 s85, 0
  s_mov_b32 s86, s72
  buffer_load_dwordx4 v[48:51], v2, s[44:47], s72 offen offset:0 nt
  buffer_load_dwordx4 v[52:55], v2, s[44:47], s72 offen offset:128 nt
  buffer_load_dwordx4 v[56:59], v2, s[44:47], s72 offen offset:256 nt
  s_barrier
L_ch_bulk:
L_pad_1:
  s_cbranch_execz L_pad_2
  s_waitcnt vmcnt(2)
  buffer_load_dwordx4 v[60:63], v2, s[44:47], s73 offen offset:0 nt
  s_waitcnt vmcnt(2)
  buffer_load_dwordx4 v[64:67], v2, s[44:47], s73 offen offset:128 nt
  s_waitcnt vmcnt(2)
  buffer_load_dwordx4 v[68:71], v2, s[44:47], s73 offen offset:256 nt
  s_waitcnt vmcnt(2)
  buffer_load_dwordx4 v[72:75], v2, s[44:47], s74 offen offset:0 nt
  s_waitcnt vmcnt(2)
  buffer_load_dwordx4 v[76:79], v2, s[44:47], s74 offen offset:128 nt
  s_waitcnt vmcnt(2)
  buffer_load_dwordx4 v[80:83], v2, s[44:47], s74 offen offset:256 nt
  s_waitcnt vmcnt(2)
  buffer_load_dwordx4 v[84:87], v2, s[44:47], s75 offen offset:0 nt
  s_waitcnt vmcnt(2)
  buffer_load_dwordx4 v[88:91], v2, s[44:47], s75 offen offset:128 nt
  s_waitcnt vmcnt(2)
  buffer_load_dwordx4 v[92:95], v2, s[44:47], s75 offen offset:256 nt
  s_waitcnt vmcnt(2)
  buffer_load_dwordx4 v[96:99], v2, s[44:47], s76 offen offset:0 nt
  s_waitcnt vmcnt(2)
  buffer_load_dwordx4 v[100:103], v2, s[44:47], s76 offen offset:128 nt
  s_waitcnt vmcnt(2)
  buffer_load_dwordx4 v[104:107], v2, s[44:47], s76 offen offset:256 nt
  s_waitcnt vmcnt(2)
  buffer_load_dwordx4 v[108:111], v2, s[44:47], s77 offen offset:0 nt
  s_waitcnt vmcnt(2)
  buffer_load_dwordx4 v[112:115], v2, s[44:47], s77 offen offset:128 nt
  s_waitcnt vmcnt(2)
  buffer_load_dwordx4 v[116:119], v2, s[44:47], s77 offen offset:256 nt
  s_waitcnt vmcnt(2)
L_pad_2:
  s_cbranch_execz L_pad_3
  buffer_load_dwordx4 v[120:123], v2, s[44:47], s78 offen offset:0 nt
  s_waitcnt vmcnt(2)
  buffer_load_dwordx4 v[124:127], v2, s[44:47], s78 offen offset:128 nt
  s_waitcnt vmcnt(2)
  buffer_load_dwordx4 v[128:131], v2, s[44:47], s78 offen offset:256 nt
  s_waitcnt vmcnt(2)
  buffer_load_dwordx4 v[132:135], v2, s[48:51], s78 offen offset:0 nt
  s_waitcnt vmcnt(2)
  buffer_load_dwordx4 v[136:139], v2, s[48:51], s78 offen offset:128 nt
  s_waitcnt vmcnt(2)
  buffer_load_dwordx4 v[140:143], v2, s[48:51], s78 offen offset:256 nt
L_vl:
  s_waitcnt vmcnt(2)
  buffer_load_dwordx4 v162, s[48:51], s86 offen nt lds
  s_add_u32 s86, s86, 1024
  s_add_u32 m0, m0, 1024
  s_add_u32 s85, s85, 1
  ds_read_b32 v144, v3 offset:0
  s_waitcnt lgkmcnt(0)
  v_readfirstlane_b32 s71, v144
  s_cmp_ge_u32 s85, 18
  s_cbranch_scc1 L_vl_done
  s_cmp_lt_u32 s85, 3
  s_cbranch_scc1 L_vl
  s_cmp_lt_u32 s71, 3
  s_cbranch_scc1 L_vl
L_vl_done:
  s_mov_b32 s90, 0
LWq_1:
  ds_read_b32 v144, v3 offset:0
  s_waitcnt lgkmcnt(0)
  v_readfirstlane_b32 s71, v144
L_pad_3:
  s_cbranch_execz L_pad_4
  s_cmp_ge_u32 s71, 3
  s_cbranch_scc1 LDq_2
  s_sleep 1
  s_add_u32 s90, s90, 1
  s_cmp_lt_u32 s90, 524288
  s_cbranch_scc1 LWq_1
LDq_2:
  v_and_b32 v144, 7, v1
  v_lshlrev_b32 v144, 4, v144
  ds_read_b128 v[4:7], v144 offset:512
  ds_read_b128 v[8:11], v144 offset:640
  ds_read_b128 v[12:15], v144 offset:768
  ds_read_b32 v145, v3 offset:16
  s_waitcnt lgkmcnt(0)
  v_readfirstlane_b32 s7, v145
  v_dot2_f32_bf16 v144, v48, v4, 0
  v_dot2_f32_bf16 v145, v52, v8, 0
  v_dot2_f32_bf16 v146, v56, v12, 0
  v_dot2_f32_bf16 v144, v49, v5, v144
  v_dot2_f32_bf16 v145, v53, v9, v145
  v_dot2_f32_bf16 v146, v57, v13, v146
  v_dot2_f32_bf16 v144, v50, v6, v144
  v_dot2_f32_bf16 v145, v54, v10, v145
  v_dot2_f32_bf16 v146, v58, v14, v146
  v_dot2_f32_bf16 v144, v51, v7, v144
  v_dot2_f32_bf16 v145, v55, v11, v145
L_pad_4:
  s_cbranch_execz L_pad_5
  v_dot2_f32_bf16 v146, v59, v15, v146
  s_nop 0
  v_add_f32 v144, v144, v145
  s_nop 0
  v_add_f32 v16, v144, v146
  v_dot2_f32_bf16 v144, v60, v4, 0
  v_dot2_f32_bf16 v145, v64, v8, 0
  v_dot2_f32_bf16 v146, v68, v12, 0
  v_dot2_f32_bf16 v144, v61, v5, v144
  v_dot2_f32_bf16 v145, v65, v9, v145
  v_dot2_f32_bf16 v146, v69, v13, v146
  v_dot2_f32_bf16 v144, v62, v6, v144
  v_dot2_f32_bf16 v145, v66, v10, v145
  v_dot2_f32_bf16 v146, v70, v14, v146
  v_dot2_f32_bf16 v144, v63, v7, v144
  v_dot2_f32_bf16 v145, v67, v11, v145
  v_dot2_f32_bf16 v146, v71, v15, v146
  s_nop 1
  v_add_f32 v144, v144, v145
  v_add_f32 v17, v144, v146
  v_dot2_f32_bf16 v144, v72, v4, 0
  v_dot2_f32_bf16 v145, v76, v8, 0
  v_dot2_f32_bf16 v146, v80, v12, 0
  v_dot2_f32_bf16 v144, v73, v5, v144
  v_dot2_f32_bf16 v145, v77, v9, v145
L_pad_5:
  s_cbranch_execz L_pad_6
  v_dot2_f32_bf16 v146, v81, v13, v146
  v_dot2_f32_bf16 v144, v74, v6, v144
  v_dot2_f32_bf16 v145, v78, v10, v145
  v_dot2_f32_bf16 v146, v82, v14, v146
  v_dot2_f32_bf16 v144, v75, v7, v144
  v_dot2_f32_bf16 v145, v79, v11, v145
  v_dot2_f32_bf16 v146, v83, v15, v146
  s_nop 1
  v_add_f32 v144, v144, v145
  v_add_f32 v18, v144, v146
  s_cmp_ge_u32 s85, 18
  s_cbranch_scc1 VLS_3
  s_waitcnt vmcnt(5)
  buffer_load_dwordx4 v162, s[48:51], s86 offen nt lds
  s_add_u32 s86, s86, 1024
  s_add_u32 m0, m0, 1024
  s_add_u32 s85, s85, 1
VLS_3:
  v_dot2_f32_bf16 v144, v84, v4, 0
  v_dot2_f32_bf16 v145, v88, v8, 0
  v_dot2_f32_bf16 v146, v92, v12, 0
  v_dot2_f32_bf16 v144, v85, v5, v144
  v_dot2_f32_bf16 v145, v89, v9, v145
  v_dot2_f32_bf16 v146, v93, v13, v146
  v_dot2_f32_bf16 v144, v86, v6, v144
  v_dot2_f32_bf16 v145, v90, v10, v145
L_pad_6:
  s_cbranch_execz L_pad_7
  v_dot2_f32_bf16 v146, v94, v14, v146
  v_dot2_f32_bf16 v144, v87, v7, v144
  v_dot2_f32_bf16 v145, v91, v11, v145
  v_dot2_f32_bf16 v146, v95, v15, v146
  s_nop 1
  v_add_f32 v144, v144, v145
  v_add_f32 v19, v144, v146
  v_dot2_f32_bf16 v144, v96, v4, 0
  v_dot2_f32_bf16 v145, v100, v8, 0
  v_dot2_f32_bf16 v146, v104, v12, 0
  v_dot2_f32_bf16 v144, v97, v5, v144
  v_dot2_f32_bf16 v145, v101, v9, v145
  v_dot2_f32_bf16 v146, v105, v13, v146
  v_dot2_f32_bf16 v144, v98, v6, v144
  v_dot2_f32_bf16 v145, v102, v10, v145
  v_dot2_f32_bf16 v146, v106, v14, v146
  v_dot2_f32_bf16 v144, v99, v7, v144
  v_dot2_f32_bf16 v145, v103, v11, v145
  v_dot2_f32_bf16 v146, v107, v15, v146
  s_nop 1
  v_add_f32 v144, v144, v145
  v_add_f32 v20, v144, v146
  v_dot2_f32_bf16 v144, v108, v4, 0
  v_dot2_f32_bf16 v145, v112, v8, 0
L_pad_7:
  s_cbranch_execz L_pad_8
  v_dot2_f32_bf16 v146, v116, v12, 0
  v_dot2_f32_bf16 v144, v109, v5, v144
  v_dot2_f32_bf16 v145, v113, v9, v145
  v_dot2_f32_bf16 v146, v117, v13, v146
  v_dot2_f32_bf16 v144, v110, v6, v144
  v_dot2_f32_bf16 v145, v114, v10, v145
  v_dot2_f32_bf16 v146, v118, v14, v146
  v_dot2_f32_bf16 v144, v111, v7, v144
  v_dot2_f32_bf16 v145, v115, v11, v145
  v_dot2_f32_bf16 v146, v119, v15, v146
  s_nop 1
  v_add_f32 v144, v144, v145
  v_add_f32 v21, v144, v146
  s_cmp_ge_u32 s85, 18
  s_cbranch_scc1 VLS_4
  s_waitcnt vmcnt(5)
  buffer_load_dwordx4 v162, s[48:51], s86 offen nt lds
  s_add_u32 s86, s86, 1024
  s_add_u32 m0, m0, 1024
  s_add_u32 s85, s85, 1
VLS_4:
  v_dot2_f32_bf16 v144, v120, v4, 0
  v_dot2_f32_bf16 v145, v124, v8, 0
  v_dot2_f32_bf16 v146, v128, v12, 0
  v_dot2_f32_bf16 v144, v121, v5, v144
  v_dot2_f32_bf16 v145, v125, v9, v145
L_pad_8:
  s_cbranch_execz L_pad_9
  v_dot2_f32_bf16 v146, v129, v13, v146
  v_dot2_f32_bf16 v144, v122, v6, v144
  v_dot2_f32_bf16 v145, v126, v10, v145
  v_dot2_f32_bf16 v146, v130, v14, v146
  v_dot2_f32_bf16 v144, v123, v7, v144
  v_dot2_f32_bf16 v145, v127, v11, v145
  v_dot2_f32_bf16 v146, v131, v15, v146
  s_nop 1
  v_add_f32 v144, v144, v145
  v_add_f32 v22, v144, v146
  v_add_f32_dpp v16, v16, v16 quad_perm:[1,0,3,2] row_mask:0xf bank_mask:0xf
  v_add_f32_dpp v17, v17, v17 quad_perm:[1,0,3,2] row_mask:0xf bank_mask:0xf
  v_add_f32_dpp v18, v18, v18 quad_perm:[1,0,3,2] row_mask:0xf bank_mask:0xf
  v_add_f32_dpp v19, v19, v19 quad_perm:[1,0,3,2] row_mask:0xf bank_mask:0xf
  v_add_f32_dpp v20, v20, v20 quad_perm:[1,0,3,2] row_mask:0xf bank_mask:0xf
  v_add_f32_dpp v21, v21, v21 quad_perm:[1,0,3,2] row_mask:0xf bank_mask:0xf
  v_add_f32_dpp v22, v22, v22 quad_perm:[1,0,3,2] row_mask:0xf bank_mask:0xf
  v_add_f32_dpp v16, v16, v16 quad_perm:[2,3,0,1] row_mask:0xf bank_mask:0xf
  v_add_f32_dpp v17, v17, v17 quad_perm:[2,3,0,1] row_mask:0xf bank_mask:0xf
  v_add_f32_dpp v18, v18, v18 quad_perm:[2,3,0,1] row_mask:0xf bank_mask:0xf
  v_add_f32_dpp v19, v19, v19 quad_perm:[2,3,0,1] row_mask:0xf bank_mask:0xf
  v_add_f32_dpp v20, v20, v20 quad_perm:[2,3,0,1] row_mask:0xf bank_mask:0xf
  v_add_f32_dpp v21, v21, v21 quad_perm:[2,3,0,1] row_mask:0xf bank_mask:0xf
  v_add_f32_dpp v22, v22, v22 quad_perm:[2,3,0,1] row_mask:0xf bank_mask:0xf
L_pad_9:
  s_cbranch_execz L_pad_10
  v_add_f32_dpp v16, v16, v16 row_half_mirror row_mask:0xf bank_mask:0xf
  v_add_f32_dpp v17, v17, v17 row_half_mirror row_mask:0xf bank_mask:0xf
  v_add_f32_dpp v18, v18, v18 row_half_mirror row_mask:0xf bank_mask:0xf
  v_add_f32_dpp v19, v19, v19 row_half_mirror row_mask:0xf bank_mask:0xf
  v_add_f32_dpp v20, v20, v20 row_half_mirror row_mask:0xf bank_mask:0xf
  v_add_f32_dpp v21, v21, v21 row_half_mirror row_mask:0xf bank_mask:0xf
  v_add_f32_dpp v22, v22, v22 row_half_mirror row_mask:0xf bank_mask:0xf
  v_cvt_pk_bf16_f32 v16, v16, v16
  v_cvt_pk_bf16_f32 v17, v17, v17
  v_cvt_pk_bf16_f32 v18, v18, v18
  v_cvt_pk_bf16_f32 v19, v19, v19
  v_cvt_pk_bf16_f32 v20, v20, v20
  v_cvt_pk_bf16_f32 v21, v21, v21
  v_cvt_pk_bf16_f32 v22, v22, v22
  v_lshlrev_b32 v16, 16, v16
  v_lshlrev_b32 v17, 16, v17
  v_lshlrev_b32 v18, 16, v18
  v_lshlrev_b32 v19, 16, v19
  v_lshlrev_b32 v20, 16, v20
  v_lshlrev_b32 v21, 16, v21
  v_lshlrev_b32 v22, 16, v22
  v_mul_f32 v16, 0x3d93cd3a, v16
  v_mul_f32 v17, 0x3d93cd3a, v17
L_pad_10:
  s_cbranch_execz L_pad_11
  v_mul_f32 v18, 0x3d93cd3a, v18
  v_mul_f32 v19, 0x3d93cd3a, v19
  v_mul_f32 v20, 0x3d93cd3a, v20
  v_mul_f32 v21, 0x3d93cd3a, v21
  v_mul_f32 v22, 0x3d93cd3a, v22
  v_cvt_pk_bf16_f32 v16, v16, v16
  v_cvt_pk_bf16_f32 v17, v17, v17
  v_cvt_pk_bf16_f32 v18, v18, v18
  v_cvt_pk_bf16_f32 v19, v19, v19
  v_cvt_pk_bf16_f32 v20, v20, v20
  v_cvt_pk_bf16_f32 v21, v21, v21
  v_cvt_pk_bf16_f32 v22, v22, v22
  v_lshlrev_b32 v16, 16, v16
  v_lshlrev_b32 v17, 16, v17
  v_lshlrev_b32 v18, 16, v18
  v_lshlrev_b32 v19, 16, v19
  v_lshlrev_b32 v20, 16, v20
  v_lshlrev_b32 v21, 16, v21
  v_lshlrev_b32 v22, 16, v22
  v_max_f32 v164, v16, v17
  v_max_f32 v164, v164, v18
  v_max_f32 v164, v164, v19
  v_max_f32 v164, v164, v20
L_pad_11:
  s_cbranch_execz L_pad_12
  v_max_f32 v164, v164, v21
  v_max_f32 v164, v164, v22
  s_nop 1
  v_max_f32_dpp v164, v164, v164 row_ror:8 row_mask:0xf bank_mask:0xf
  v_mov_b32 v154, v164
  s_nop 1
  v_permlane16_swap_b32 v154, v164
  v_max_f32 v164, v154, v164
  v_mov_b32 v154, v164
  s_nop 1
  v_permlane32_swap_b32 v154, v164
  v_max_f32 v164, v154, v164
  v_sub_f32 v16, v16, v164
  v_sub_f32 v17, v17, v164
  v_sub_f32 v18, v18, v164
  v_sub_f32 v19, v19, v164
  v_sub_f32 v20, v20, v164
  v_sub_f32 v21, v21, v164
  v_sub_f32 v22, v22, v164
  v_mul_f32 v16, 0x3fb8aa3b, v16
  v_mul_f32 v17, 0x3fb8aa3b, v17
  v_mul_f32 v18, 0x3fb8aa3b, v18
  v_mul_f32 v19, 0x3fb8aa3b, v19
  v_mul_f32 v20, 0x3fb8aa3b, v20
  v_mul_f32 v21, 0x3fb8aa3b, v21
L_pad_12:
  s_cbranch_execz L_pad_13
  v_mul_f32 v22, 0x3fb8aa3b, v22
  v_exp_f32 v16, v16
  v_exp_f32 v17, v17
  v_exp_f32 v18, v18
  v_exp_f32 v19, v19
  v_exp_f32 v20, v20
  v_exp_f32 v21, v21
  v_exp_f32 v22, v22
  v_add_f32 v165, v16, v17
  v_add_f32 v165, v165, v18
  v_add_f32 v165, v165, v19
  v_add_f32 v165, v165, v20
  v_add_f32 v165, v165, v21
  v_add_f32 v165, v165, v22
  v_cvt_pk_bf16_f32 v16, v16, 0
  v_cvt_pk_bf16_f32 v17, v17, 0
  v_cvt_pk_bf16_f32 v18, v18, 0
  v_cvt_pk_bf16_f32 v19, v19, 0
  v_cvt_pk_bf16_f32 v20, v20, 0
  v_cvt_pk_bf16_f32 v21, v21, 0
  v_cvt_pk_bf16_f32 v22, v22, 0
  v_lshlrev_b32 v144, 16, v16
  v_lshlrev_b32 v145, 16, v17
L_pad_13:
  s_cbranch_execz L_pad_14
  v_lshlrev_b32 v146, 16, v18
  v_lshlrev_b32 v147, 16, v19
  v_lshlrev_b32 v148, 16, v20
  v_lshlrev_b32 v149, 16, v21
  v_lshlrev_b32 v150, 16, v22
  v_add_f32_dpp v165, v165, v165 row_ror:8 row_mask:0xf bank_mask:0xf
  v_mov_b32 v154, v165
  s_nop 1
  v_permlane16_swap_b32 v154, v165
  v_add_f32 v165, v154, v165
  v_mov_b32 v154, v165
  s_nop 1
  v_permlane32_swap_b32 v154, v165
  v_add_f32 v165, v154, v165
  s_lshl_b32 s95, s5, 9
  s_cmp_lt_u32 s8, 160
  s_cselect_b32 s87, 1, 0
  s_cmp_ge_u32 s8, 208
  s_cselect_b32 s87, 1, s87
L_vl1:
  s_cmp_ge_u32 s85, 16
  s_cbranch_scc1 L_vl1_done
  s_waitcnt vmcnt(5)
  buffer_load_dwordx4 v162, s[48:51], s86 offen nt lds
  s_add_u32 s86, s86, 1024
  s_add_u32 m0, m0, 1024
L_pad_14:
  s_cbranch_execz L_pad_15
  s_add_u32 s85, s85, 1
  s_branch L_vl1
L_vl1_done:
  v_mov_b32 v166, 1
  s_mov_b64 exec, 1
  buffer_atomic_add v166, v3, s[64:67], s95 offen sc0 sc1
  s_mov_b64 exec, -1
  s_sub_u32 s94, 18, s85
L_vl2:
  s_cmp_ge_u32 s85, 18
  s_cbranch_scc1 L_vl2_done
  s_waitcnt vmcnt(5)
  buffer_load_dwordx4 v162, s[48:51], s86 offen nt lds
  s_add_u32 s86, s86, 1024
  s_add_u32 m0, m0, 1024
  s_add_u32 s85, s85, 1
  s_branch L_vl2
L_vl2_done:
  s_cmp_lg_u32 s94, 0
  s_cbranch_scc1 CW_5
  s_waitcnt vmcnt(0)
  s_branch L_cw_done
CW_5:
  s_cmp_lg_u32 s94, 1
  s_cbranch_scc1 CW_6
  s_waitcnt vmcnt(1)
  s_branch L_cw_done
CW_6:
  s_cmp_lg_u32 s94, 2
  s_cbranch_scc1 CW_7
  s_waitcnt vmcnt(2)
  s_branch L_cw_done
CW_7:
  s_cmp_lg_u32 s94, 3
  s_cbranch_scc1 CW_8
  s_waitcnt vmcnt(3)
  s_branch L_cw_done
CW_8:
L_pad_15:
  s_cbranch_execz L_pad_16
  s_cmp_lg_u32 s94, 4
  s_cbranch_scc1 CW_9
  s_waitcnt vmcnt(4)
  s_branch L_cw_done
CW_9:
  s_cmp_lg_u32 s94, 5
  s_cbranch_scc1 CW_10
  s_waitcnt vmcnt(5)
  s_branch L_cw_done
CW_10:
L_cw_done:
  s_nop 0
  v_readfirstlane_b32 s71, v166
  s_cmp_ge_u32 s71, 64
  s_cbranch_scc1 NW_11
  s_add_u32 s71, s71, 448
  s_mul_i32 s71, s71, 3072
  s_nop 0
  buffer_load_dwordx4 v[48:51], v2, s[44:47], s71 offen offset:0 nt
  buffer_load_dwordx4 v[52:55], v2, s[44:47], s71 offen offset:128 nt
  buffer_load_dwordx4 v[56:59], v2, s[44:47], s71 offen offset:256 nt
  buffer_load_dwordx4 v[60:63], v2, s[48:51], s71 offen offset:0 nt
  buffer_load_dwordx4 v[64:67], v2, s[48:51], s71 offen offset:128 nt
  buffer_load_dwordx4 v[68:71], v2, s[48:51], s71 offen offset:256 nt
  s_mov_b32 s91, 2
  s_branch ND_12
NW_11:
  s_mov_b32 s91, s87
  s_cmp_eq_u32 s87, 0
  s_cbranch_scc1 ND_12
  buffer_load_dwordx4 v[96:99], v161, s[52:55], s80 offen nt
  s_add_u32 s80, s80, s81
  buffer_load_dwordx4 v[100:103], v161, s[52:55], s80 offen nt
L_pad_16:
  s_cbranch_execz L_pad_17
  s_add_u32 s80, s80, s81
  buffer_load_dwordx4 v[104:107], v161, s[52:55], s80 offen nt
  s_add_u32 s80, s80, s83
  buffer_load_dwordx4 v[108:111], v161, s[52:55], s80 offen nt
  s_add_u32 s80, s80, s81
ND_12:
  s_cmp_eq_u32 s91, 2
  s_cbranch_scc1 L_w7
  s_cmp_eq_u32 s91, 1
  s_cbranch_scc1 L_w4
  s_waitcnt vmcnt(0)
  s_branch L_wd
L_w4:
  s_waitcnt vmcnt(4)
  s_branch L_wd
L_w7:
  s_waitcnt vmcnt(6)
  v_mov_b32 v166, 1
  s_mov_b64 exec, 1
  buffer_atomic_add v166, v3, s[64:67], s95 offen sc0 sc1
  s_mov_b64 exec, -1
L_wd:
  ds_read_b128 v[72:75], v163 offset:0
  ds_read_b128 v[76:79], v163 offset:128
  ds_read_b128 v[80:83], v163 offset:256
  ds_read_b128 v[84:87], v163 offset:3072
  ds_read_b128 v[88:91], v163 offset:3200
  ds_read_b128 v[92:95], v163 offset:3328
  v_dot2_f32_bf16 v24, v132, v22, 0
  v_dot2_f32_bf16 v25, v132, v150, 0
  v_dot2_f32_bf16 v26, v133, v22, 0
L_pad_17:
  s_cbranch_execz L_pad_18
  v_dot2_f32_bf16 v27, v133, v150, 0
  v_dot2_f32_bf16 v28, v134, v22, 0
  v_dot2_f32_bf16 v29, v134, v150, 0
  v_dot2_f32_bf16 v30, v135, v22, 0
  v_dot2_f32_bf16 v31, v135, v150, 0
  v_dot2_f32_bf16 v32, v136, v22, 0
  v_dot2_f32_bf16 v33, v136, v150, 0
  v_dot2_f32_bf16 v34, v137, v22, 0
  v_dot2_f32_bf16 v35, v137, v150, 0
  v_dot2_f32_bf16 v36, v138, v22, 0
  v_dot2_f32_bf16 v37, v138, v150, 0
  v_dot2_f32_bf16 v38, v139, v22, 0
  v_dot2_f32_bf16 v39, v139, v150, 0
  v_dot2_f32_bf16 v40, v140, v22, 0
  v_dot2_f32_bf16 v41, v140, v150, 0
  v_dot2_f32_bf16 v42, v141, v22, 0
  v_dot2_f32_bf16 v43, v141, v150, 0
  v_dot2_f32_bf16 v44, v142, v22, 0
  v_dot2_f32_bf16 v45, v142, v150, 0
  v_dot2_f32_bf16 v46, v143, v22, 0
  v_dot2_f32_bf16 v47, v143, v150, 0
  s_waitcnt lgkmcnt(3)
  v_dot2_f32_bf16 v24, v72, v16, v24
  v_dot2_f32_bf16 v25, v72, v144, v25
L_pad_18:
  s_cbranch_execz L_pad_19
  v_dot2_f32_bf16 v26, v73, v16, v26
  v_dot2_f32_bf16 v27, v73, v144, v27
  v_dot2_f32_bf16 v28, v74, v16, v28
  v_dot2_f32_bf16 v29, v74, v144, v29
  v_dot2_f32_bf16 v30, v75, v16, v30
  v_dot2_f32_bf16 v31, v75, v144, v31
  v_dot2_f32_bf16 v32, v76, v16, v32
  v_dot2_f32_bf16 v33, v76, v144, v33
  v_dot2_f32_bf16 v34, v77, v16, v34
  v_dot2_f32_bf16 v35, v77, v144, v35
  v_dot2_f32_bf16 v36, v78, v16, v36
  v_dot2_f32_bf16 v37, v78, v144, v37
  v_dot2_f32_bf16 v38, v79, v16, v38
  v_dot2_f32_bf16 v39, v79, v144, v39
  v_dot2_f32_bf16 v40, v80, v16, v40
  v_dot2_f32_bf16 v41, v80, v144, v41
  v_dot2_f32_bf16 v42, v81, v16, v42
  v_dot2_f32_bf16 v43, v81, v144, v43
  v_dot2_f32_bf16 v44, v82, v16, v44
  v_dot2_f32_bf16 v45, v82, v144, v45
  v_dot2_f32_bf16 v46, v83, v16, v46
  v_dot2_f32_bf16 v47, v83, v144, v47
  ds_read_b128 v[72:75], v163 offset:6144
L_pad_19:
  s_cbranch_execz L_pad_20
  ds_read_b128 v[76:79], v163 offset:6272
  ds_read_b128 v[80:83], v163 offset:6400
  s_waitcnt lgkmcnt(3)
  v_dot2_f32_bf16 v24, v84, v17, v24
  v_dot2_f32_bf16 v25, v84, v145, v25
  v_dot2_f32_bf16 v26, v85, v17, v26
  v_dot2_f32_bf16 v27, v85, v145, v27
  v_dot2_f32_bf16 v28, v86, v17, v28
  v_dot2_f32_bf16 v29, v86, v145, v29
  v_dot2_f32_bf16 v30, v87, v17, v30
  v_dot2_f32_bf16 v31, v87, v145, v31
  v_dot2_f32_bf16 v32, v88, v17, v32
  v_dot2_f32_bf16 v33, v88, v145, v33
  v_dot2_f32_bf16 v34, v89, v17, v34
  v_dot2_f32_bf16 v35, v89, v145, v35
  v_dot2_f32_bf16 v36, v90, v17, v36
  v_dot2_f32_bf16 v37, v90, v145, v37
  v_dot2_f32_bf16 v38, v91, v17, v38
  v_dot2_f32_bf16 v39, v91, v145, v39
  v_dot2_f32_bf16 v40, v92, v17, v40
  v_dot2_f32_bf16 v41, v92, v145, v41
  v_dot2_f32_bf16 v42, v93, v17, v42
  v_dot2_f32_bf16 v43, v93, v145, v43
  v_dot2_f32_bf16 v44, v94, v17, v44
L_pad_20:
  s_cbranch_execz L_pad_21
  v_dot2_f32_bf16 v45, v94, v145, v45
  v_dot2_f32_bf16 v46, v95, v17, v46
  v_dot2_f32_bf16 v47, v95, v145, v47
  ds_read_b128 v[84:87], v163 offset:9216
  ds_read_b128 v[88:91], v163 offset:9344
  ds_read_b128 v[92:95], v163 offset:9472
  s_waitcnt lgkmcnt(3)
  v_dot2_f32_bf16 v24, v72, v18, v24
  v_dot2_f32_bf16 v25, v72, v146, v25
  v_dot2_f32_bf16 v26, v73, v18, v26
  v_dot2_f32_bf16 v27, v73, v146, v27
  v_dot2_f32_bf16 v28, v74, v18, v28
  v_dot2_f32_bf16 v29, v74, v146, v29
  v_dot2_f32_bf16 v30, v75, v18, v30
  v_dot2_f32_bf16 v31, v75, v146, v31
  v_dot2_f32_bf16 v32, v76, v18, v32
  v_dot2_f32_bf16 v33, v76, v146, v33
  v_dot2_f32_bf16 v34, v77, v18, v34
  v_dot2_f32_bf16 v35, v77, v146, v35
  v_dot2_f32_bf16 v36, v78, v18, v36
  v_dot2_f32_bf16 v37, v78, v146, v37
  v_dot2_f32_bf16 v38, v79, v18, v38
  v_dot2_f32_bf16 v39, v79, v146, v39
  v_dot2_f32_bf16 v40, v80, v18, v40
L_pad_21:
  s_cbranch_execz L_pad_22
  v_dot2_f32_bf16 v41, v80, v146, v41
  v_dot2_f32_bf16 v42, v81, v18, v42
  v_dot2_f32_bf16 v43, v81, v146, v43
  v_dot2_f32_bf16 v44, v82, v18, v44
  v_dot2_f32_bf16 v45, v82, v146, v45
  v_dot2_f32_bf16 v46, v83, v18, v46
  v_dot2_f32_bf16 v47, v83, v146, v47
  ds_read_b128 v[72:75], v163 offset:12288
  ds_read_b128 v[76:79], v163 offset:12416
  ds_read_b128 v[80:83], v163 offset:12544
  s_waitcnt lgkmcnt(3)
  v_dot2_f32_bf16 v24, v84, v19, v24
  v_dot2_f32_bf16 v25, v84, v147, v25
  v_dot2_f32_bf16 v26, v85, v19, v26
  v_dot2_f32_bf16 v27, v85, v147, v27
  v_dot2_f32_bf16 v28, v86, v19, v28
  v_dot2_f32_bf16 v29, v86, v147, v29
  v_dot2_f32_bf16 v30, v87, v19, v30
  v_dot2_f32_bf16 v31, v87, v147, v31
  v_dot2_f32_bf16 v32, v88, v19, v32
  v_dot2_f32_bf16 v33, v88, v147, v33
  v_dot2_f32_bf16 v34, v89, v19, v34
  v_dot2_f32_bf16 v35, v89, v147, v35
  v_dot2_f32_bf16 v36, v90, v19, v36
L_pad_22:
  s_cbranch_execz L_pad_23
  v_dot2_f32_bf16 v37, v90, v147, v37
  v_dot2_f32_bf16 v38, v91, v19, v38
  v_dot2_f32_bf16 v39, v91, v147, v39
  v_dot2_f32_bf16 v40, v92, v19, v40
  v_dot2_f32_bf16 v41, v92, v147, v41
  v_dot2_f32_bf16 v42, v93, v19, v42
  v_dot2_f32_bf16 v43, v93, v147, v43
  v_dot2_f32_bf16 v44, v94, v19, v44
  v_dot2_f32_bf16 v45, v94, v147, v45
  v_dot2_f32_bf16 v46, v95, v19, v46
  v_dot2_f32_bf16 v47, v95, v147, v47
  ds_read_b128 v[84:87], v163 offset:15360
  ds_read_b128 v[88:91], v163 offset:15488
  ds_read_b128 v[92:95], v163 offset:15616
  s_waitcnt lgkmcnt(3)
  v_dot2_f32_bf16 v24, v72, v20, v24
  v_dot2_f32_bf16 v25, v72, v148, v25
  v_dot2_f32_bf16 v26, v73, v20, v26
  v_dot2_f32_bf16 v27, v73, v148, v27
  v_dot2_f32_bf16 v28, v74, v20, v28
  v_dot2_f32_bf16 v29, v74, v148, v29
  v_dot2_f32_bf16 v30, v75, v20, v30
  v_dot2_f32_bf16 v31, v75, v148, v31
  v_dot2_f32_bf16 v32, v76, v20, v32
L_pad_23:
  s_cbranch_execz L_pad_24
  v_dot2_f32_bf16 v33, v76, v148, v33
  v_dot2_f32_bf16 v34, v77, v20, v34
  v_dot2_f32_bf16 v35, v77, v148, v35
  v_dot2_f32_bf16 v36, v78, v20, v36
  v_dot2_f32_bf16 v37, v78, v148, v37
  v_dot2_f32_bf16 v38, v79, v20, v38
  v_dot2_f32_bf16 v39, v79, v148, v39
  v_dot2_f32_bf16 v40, v80, v20, v40
  v_dot2_f32_bf16 v41, v80, v148, v41
  v_dot2_f32_bf16 v42, v81, v20, v42
  v_dot2_f32_bf16 v43, v81, v148, v43
  v_dot2_f32_bf16 v44, v82, v20, v44
  v_dot2_f32_bf16 v45, v82, v148, v45
  v_dot2_f32_bf16 v46, v83, v20, v46
  v_dot2_f32_bf16 v47, v83, v148, v47
  s_waitcnt lgkmcnt(0)
  v_dot2_f32_bf16 v24, v84, v21, v24
  v_dot2_f32_bf16 v25, v84, v149, v25
  v_dot2_f32_bf16 v26, v85, v21, v26
  v_dot2_f32_bf16 v27, v85, v149, v27
  v_dot2_f32_bf16 v28, v86, v21, v28
  v_dot2_f32_bf16 v29, v86, v149, v29
  v_dot2_f32_bf16 v30, v87, v21, v30
  v_dot2_f32_bf16 v31, v87, v149, v31
L_pad_24:
  s_cbranch_execz L_pad_25
  v_dot2_f32_bf16 v32, v88, v21, v32
  v_dot2_f32_bf16 v33, v88, v149, v33
  v_dot2_f32_bf16 v34, v89, v21, v34
  v_dot2_f32_bf16 v35, v89, v149, v35
  v_dot2_f32_bf16 v36, v90, v21, v36
  v_dot2_f32_bf16 v37, v90, v149, v37
  v_dot2_f32_bf16 v38, v91, v21, v38
  v_dot2_f32_bf16 v39, v91, v149, v39
  v_dot2_f32_bf16 v40, v92, v21, v40
  v_dot2_f32_bf16 v41, v92, v149, v41
  v_dot2_f32_bf16 v42, v93, v21, v42
  v_dot2_f32_bf16 v43, v93, v149, v43
  v_dot2_f32_bf16 v44, v94, v21, v44
  v_dot2_f32_bf16 v45, v94, v149, v45
  v_dot2_f32_bf16 v46, v95, v21, v46
  v_dot2_f32_bf16 v47, v95, v149, v47
  s_cmp_lg_u32 s91, 2
  s_cbranch_scc1 L_dyn_end
  s_waitcnt vmcnt(0)
  v_readfirstlane_b32 s71, v166
  s_cmp_ge_u32 s71, 64
  s_cbranch_scc1 NW_13
  s_add_u32 s71, s71, 448
  s_mul_i32 s71, s71, 3072
  v_mov_b32 v166, 1
L_pad_25:
  s_cbranch_execz L_pad_26
  s_mov_b64 exec, 1
  buffer_atomic_add v166, v3, s[64:67], s95 offen sc0 sc1
  s_mov_b64 exec, -1
  buffer_load_dwordx4 v[72:75], v2, s[44:47], s71 offen offset:0 nt
  buffer_load_dwordx4 v[76:79], v2, s[44:47], s71 offen offset:128 nt
  buffer_load_dwordx4 v[80:83], v2, s[44:47], s71 offen offset:256 nt
  buffer_load_dwordx4 v[84:87], v2, s[48:51], s71 offen offset:0 nt
  buffer_load_dwordx4 v[88:91], v2, s[48:51], s71 offen offset:128 nt
  buffer_load_dwordx4 v[92:95], v2, s[48:51], s71 offen offset:256 nt
  s_mov_b32 s91, 2
  s_branch ND_14
NW_13:
  s_mov_b32 s91, s87
  s_cmp_eq_u32 s87, 0
  s_cbranch_scc1 ND_14
  buffer_load_dwordx4 v[96:99], v161, s[52:55], s80 offen nt
  s_add_u32 s80, s80, s81
  buffer_load_dwordx4 v[100:103], v161, s[52:55], s80 offen nt
  s_add_u32 s80, s80, s81
  buffer_load_dwordx4 v[104:107], v161, s[52:55], s80 offen nt
  s_add_u32 s80, s80, s83
  buffer_load_dwordx4 v[108:111], v161, s[52:55], s80 offen nt
  s_add_u32 s80, s80, s81
ND_14:
  v_dot2_f32_bf16 v152, v48, v4, 0
  v_dot2_f32_bf16 v153, v52, v8, 0
L_pad_26:
  s_cbranch_execz L_pad_27
  v_dot2_f32_bf16 v154, v56, v12, 0
  v_dot2_f32_bf16 v152, v49, v5, v152
  v_dot2_f32_bf16 v153, v53, v9, v153
  v_dot2_f32_bf16 v154, v57, v13, v154
  v_dot2_f32_bf16 v152, v50, v6, v152
  v_dot2_f32_bf16 v153, v54, v10, v153
  v_dot2_f32_bf16 v154, v58, v14, v154
  v_dot2_f32_bf16 v152, v51, v7, v152
  v_dot2_f32_bf16 v153, v55, v11, v153
  v_dot2_f32_bf16 v154, v59, v15, v154
  s_nop 1
  v_add_f32 v152, v152, v153
  v_add_f32 v152, v152, v154
  s_nop 1
  v_add_f32_dpp v152, v152, v152 quad_perm:[1,0,3,2] row_mask:0xf bank_mask:0xf
  s_nop 1
  v_add_f32_dpp v152, v152, v152 quad_perm:[2,3,0,1] row_mask:0xf bank_mask:0xf
  s_nop 1
  v_add_f32_dpp v152, v152, v152 row_half_mirror row_mask:0xf bank_mask:0xf
  v_cvt_pk_bf16_f32 v152, v152, v152
  v_lshlrev_b32 v152, 16, v152
  v_mul_f32 v152, 0x3d93cd3a, v152
  v_cvt_pk_bf16_f32 v152, v152, v152
  v_lshlrev_b32 v152, 16, v152
  v_max_f32 v155, v152, v164
L_pad_27:
  s_cbranch_execz L_pad_28
  s_nop 0
  v_max_f32_dpp v155, v155, v155 row_ror:8 row_mask:0xf bank_mask:0xf
  v_mov_b32 v157, v155
  s_nop 1
  v_permlane16_swap_b32 v157, v155
  v_max_f32 v155, v157, v155
  v_mov_b32 v157, v155
  s_nop 1
  v_permlane32_swap_b32 v157, v155
  v_max_f32 v155, v157, v155
  v_sub_f32 v156, v164, v155
  v_sub_f32 v152, v152, v155
  v_mul_f32 v156, 0x3fb8aa3b, v156
  v_mul_f32 v152, 0x3fb8aa3b, v152
  v_exp_f32 v156, v156
  v_exp_f32 v152, v152
  v_mov_b32 v164, v155
  v_cvt_pk_bf16_f32 v153, v152, 0
  v_lshlrev_b32 v154, 16, v153
  v_mul_f32 v24, v24, v156
  v_mul_f32 v25, v25, v156
  v_mul_f32 v26, v26, v156
  v_mul_f32 v27, v27, v156
  v_mul_f32 v28, v28, v156
  v_mul_f32 v29, v29, v156
L_pad_28:
  s_cbranch_execz L_pad_29
  v_mul_f32 v30, v30, v156
  v_mul_f32 v31, v31, v156
  v_mul_f32 v32, v32, v156
  v_mul_f32 v33, v33, v156
  v_mul_f32 v34, v34, v156
  v_mul_f32 v35, v35, v156
  v_mul_f32 v36, v36, v156
  v_mul_f32 v37, v37, v156
  v_mul_f32 v38, v38, v156
  v_mul_f32 v39, v39, v156
  v_mul_f32 v40, v40, v156
  v_mul_f32 v41, v41, v156
  v_mul_f32 v42, v42, v156
  v_mul_f32 v43, v43, v156
  v_mul_f32 v44, v44, v156
  v_mul_f32 v45, v45, v156
  v_mul_f32 v46, v46, v156
  v_mul_f32 v47, v47, v156
  v_add_f32_dpp v152, v152, v152 row_ror:8 row_mask:0xf bank_mask:0xf
  v_mov_b32 v157, v152
  s_nop 1
  v_permlane16_swap_b32 v157, v152
  v_add_f32 v152, v157, v152
  v_mov_b32 v157, v152
L_pad_29:
  s_cbranch_execz L_pad_30
  s_nop 0
  v_permlane32_swap_b32 v157, v152
  v_add_f32 v152, v157, v152
  v_fma_f32 v165, v165, v156, v152
  v_dot2_f32_bf16 v24, v60, v153, v24
  v_dot2_f32_bf16 v25, v60, v154, v25
  v_dot2_f32_bf16 v26, v61, v153, v26
  v_dot2_f32_bf16 v27, v61, v154, v27
  v_dot2_f32_bf16 v28, v62, v153, v28
  v_dot2_f32_bf16 v29, v62, v154, v29
  v_dot2_f32_bf16 v30, v63, v153, v30
  v_dot2_f32_bf16 v31, v63, v154, v31
  v_dot2_f32_bf16 v32, v64, v153, v32
  v_dot2_f32_bf16 v33, v64, v154, v33
  v_dot2_f32_bf16 v34, v65, v153, v34
  v_dot2_f32_bf16 v35, v65, v154, v35
  v_dot2_f32_bf16 v36, v66, v153, v36
  v_dot2_f32_bf16 v37, v66, v154, v37
  v_dot2_f32_bf16 v38, v67, v153, v38
  v_dot2_f32_bf16 v39, v67, v154, v39
  v_dot2_f32_bf16 v40, v68, v153, v40
  v_dot2_f32_bf16 v41, v68, v154, v41
  v_dot2_f32_bf16 v42, v69, v153, v42
  v_dot2_f32_bf16 v43, v69, v154, v43
L_pad_30:
  s_cbranch_execz L_pad_31
  v_dot2_f32_bf16 v44, v70, v153, v44
  v_dot2_f32_bf16 v45, v70, v154, v45
  v_dot2_f32_bf16 v46, v71, v153, v46
  v_dot2_f32_bf16 v47, v71, v154, v47
L_dyn0:
  s_cmp_lg_u32 s91, 2
  s_cbranch_scc1 L_dyn_end
  s_waitcnt vmcnt(6)
  v_readfirstlane_b32 s71, v166
  s_cmp_ge_u32 s71, 64
  s_cbranch_scc1 NW_15
  s_add_u32 s71, s71, 448
  s_mul_i32 s71, s71, 3072
  v_mov_b32 v166, 1
  s_mov_b64 exec, 1
  buffer_atomic_add v166, v3, s[64:67], s95 offen sc0 sc1
  s_mov_b64 exec, -1
  buffer_load_dwordx4 v[48:51], v2, s[44:47], s71 offen offset:0 nt
  buffer_load_dwordx4 v[52:55], v2, s[44:47], s71 offen offset:128 nt
  buffer_load_dwordx4 v[56:59], v2, s[44:47], s71 offen offset:256 nt
  buffer_load_dwordx4 v[60:63], v2, s[48:51], s71 offen offset:0 nt
  buffer_load_dwordx4 v[64:67], v2, s[48:51], s71 offen offset:128 nt
  buffer_load_dwordx4 v[68:71], v2, s[48:51], s71 offen offset:256 nt
  s_mov_b32 s91, 2
  s_branch ND_16
NW_15:
  s_mov_b32 s91, s87
L_pad_31:
  s_cbranch_execz L_pad_32
  s_cmp_eq_u32 s87, 0
  s_cbranch_scc1 ND_16
  buffer_load_dwordx4 v[96:99], v161, s[52:55], s80 offen nt
  s_add_u32 s80, s80, s81
  buffer_load_dwordx4 v[100:103], v161, s[52:55], s80 offen nt
  s_add_u32 s80, s80, s81
  buffer_load_dwordx4 v[104:107], v161, s[52:55], s80 offen nt
  s_add_u32 s80, s80, s83
  buffer_load_dwordx4 v[108:111], v161, s[52:55], s80 offen nt
  s_add_u32 s80, s80, s81
ND_16:
  s_cmp_eq_u32 s91, 2
  s_cbranch_scc1 WA_17
  s_cmp_eq_u32 s91, 1
  s_cbranch_scc1 WB_18
  s_waitcnt vmcnt(0)
  s_branch WC_19
WB_18:
  s_waitcnt vmcnt(4)
  s_branch WC_19
WA_17:
  s_waitcnt vmcnt(7)
WC_19:
  v_dot2_f32_bf16 v152, v72, v4, 0
  v_dot2_f32_bf16 v153, v76, v8, 0
  v_dot2_f32_bf16 v154, v80, v12, 0
  v_dot2_f32_bf16 v152, v73, v5, v152
  v_dot2_f32_bf16 v153, v77, v9, v153
  v_dot2_f32_bf16 v154, v81, v13, v154
  v_dot2_f32_bf16 v152, v74, v6, v152
  v_dot2_f32_bf16 v153, v78, v10, v153
L_pad_32:
  s_cbranch_execz L_pad_33
  v_dot2_f32_bf16 v154, v82, v14, v154
  v_dot2_f32_bf16 v152, v75, v7, v152
  v_dot2_f32_bf16 v153, v79, v11, v153
  v_dot2_f32_bf16 v154, v83, v15, v154
  s_nop 1
  v_add_f32 v152, v152, v153
  v_add_f32 v152, v152, v154
  s_nop 1
  v_add_f32_dpp v152, v152, v152 quad_perm:[1,0,3,2] row_mask:0xf bank_mask:0xf
  s_nop 1
  v_add_f32_dpp v152, v152, v152 quad_perm:[2,3,0,1] row_mask:0xf bank_mask:0xf
  s_nop 1
  v_add_f32_dpp v152, v152, v152 row_half_mirror row_mask:0xf bank_mask:0xf
  v_cvt_pk_bf16_f32 v152, v152, v152
  v_lshlrev_b32 v152, 16, v152
  v_mul_f32 v152, 0x3d93cd3a, v152
  v_cvt_pk_bf16_f32 v152, v152, v152
  v_lshlrev_b32 v152, 16, v152
  v_max_f32 v155, v152, v164
  s_nop 1
  v_max_f32_dpp v155, v155, v155 row_ror:8 row_mask:0xf bank_mask:0xf
  v_mov_b32 v157, v155
  s_nop 1
  v_permlane16_swap_b32 v157, v155
  v_max_f32 v155, v157, v155
  v_mov_b32 v157, v155
L_pad_33:
  s_cbranch_execz L_pad_34
  s_nop 0
  v_permlane32_swap_b32 v157, v155
  v_max_f32 v155, v157, v155
  v_sub_f32 v156, v164, v155
  v_sub_f32 v152, v152, v155
  v_mul_f32 v156, 0x3fb8aa3b, v156
  v_mul_f32 v152, 0x3fb8aa3b, v152
  v_exp_f32 v156, v156
  v_exp_f32 v152, v152
  v_mov_b32 v164, v155
  v_cvt_pk_bf16_f32 v153, v152, 0
  v_lshlrev_b32 v154, 16, v153
  v_mul_f32 v24, v24, v156
  v_mul_f32 v25, v25, v156
  v_mul_f32 v26, v26, v156
  v_mul_f32 v27, v27, v156
  v_mul_f32 v28, v28, v156
  v_mul_f32 v29, v29, v156
  v_mul_f32 v30, v30, v156
  v_mul_f32 v31, v31, v156
  v_mul_f32 v32, v32, v156
  v_mul_f32 v33, v33, v156
  v_mul_f32 v34, v34, v156
  v_mul_f32 v35, v35, v156
L_pad_34:
  s_cbranch_execz L_pad_35
  v_mul_f32 v36, v36, v156
  v_mul_f32 v37, v37, v156
  v_mul_f32 v38, v38, v156
  v_mul_f32 v39, v39, v156
  v_mul_f32 v40, v40, v156
  v_mul_f32 v41, v41, v156
  v_mul_f32 v42, v42, v156
  v_mul_f32 v43, v43, v156
  v_mul_f32 v44, v44, v156
  v_mul_f32 v45, v45, v156
  v_mul_f32 v46, v46, v156
  v_mul_f32 v47, v47, v156
  v_add_f32_dpp v152, v152, v152 row_ror:8 row_mask:0xf bank_mask:0xf
  v_mov_b32 v157, v152
  s_nop 1
  v_permlane16_swap_b32 v157, v152
  v_add_f32 v152, v157, v152
  v_mov_b32 v157, v152
  s_nop 1
  v_permlane32_swap_b32 v157, v152
  v_add_f32 v152, v157, v152
  v_fma_f32 v165, v165, v156, v152
  v_dot2_f32_bf16 v24, v84, v153, v24
  v_dot2_f32_bf16 v25, v84, v154, v25
L_pad_35:
  s_cbranch_execz L_pad_36
  v_dot2_f32_bf16 v26, v85, v153, v26
  v_dot2_f32_bf16 v27, v85, v154, v27
  v_dot2_f32_bf16 v28, v86, v153, v28
  v_dot2_f32_bf16 v29, v86, v154, v29
  v_dot2_f32_bf16 v30, v87, v153, v30
  v_dot2_f32_bf16 v31, v87, v154, v31
  v_dot2_f32_bf16 v32, v88, v153, v32
  v_dot2_f32_bf16 v33, v88, v154, v33
  v_dot2_f32_bf16 v34, v89, v153, v34
  v_dot2_f32_bf16 v35, v89, v154, v35
  v_dot2_f32_bf16 v36, v90, v153, v36
  v_dot2_f32_bf16 v37, v90, v154, v37
  v_dot2_f32_bf16 v38, v91, v153, v38
  v_dot2_f32_bf16 v39, v91, v154, v39
  v_dot2_f32_bf16 v40, v92, v153, v40
  v_dot2_f32_bf16 v41, v92, v154, v41
  v_dot2_f32_bf16 v42, v93, v153, v42
  v_dot2_f32_bf16 v43, v93, v154, v43
  v_dot2_f32_bf16 v44, v94, v153, v44
  v_dot2_f32_bf16 v45, v94, v154, v45
  v_dot2_f32_bf16 v46, v95, v153, v46
  v_dot2_f32_bf16 v47, v95, v154, v47
  s_cmp_lg_u32 s91, 2
L_pad_36:
  s_cbranch_execz L_pad_37
  s_cbranch_scc1 L_dyn_end
  s_waitcnt vmcnt(6)
  v_readfirstlane_b32 s71, v166
  s_cmp_ge_u32 s71, 64
  s_cbranch_scc1 NW_20
  s_add_u32 s71, s71, 448
  s_mul_i32 s71, s71, 3072
  v_mov_b32 v166, 1
  s_mov_b64 exec, 1
  buffer_atomic_add v166, v3, s[64:67], s95 offen sc0 sc1
  s_mov_b64 exec, -1
  buffer_load_dwordx4 v[72:75], v2, s[44:47], s71 offen offset:0 nt
  buffer_load_dwordx4 v[76:79], v2, s[44:47], s71 offen offset:128 nt
  buffer_load_dwordx4 v[80:83], v2, s[44:47], s71 offen offset:256 nt
  buffer_load_dwordx4 v[84:87], v2, s[48:51], s71 offen offset:0 nt
  buffer_load_dwordx4 v[88:91], v2, s[48:51], s71 offen offset:128 nt
  buffer_load_dwordx4 v[92:95], v2, s[48:51], s71 offen offset:256 nt
  s_mov_b32 s91, 2
  s_branch ND_21
NW_20:
  s_mov_b32 s91, s87
  s_cmp_eq_u32 s87, 0
  s_cbranch_scc1 ND_21
  buffer_load_dwordx4 v[96:99], v161, s[52:55], s80 offen nt
  s_add_u32 s80, s80, s81
  buffer_load_dwordx4 v[100:103], v161, s[52:55], s80 offen nt
  s_add_u32 s80, s80, s81
L_pad_37:
  s_cbranch_execz L_pad_38
  buffer_load_dwordx4 v[104:107], v161, s[52:55], s80 offen nt
  s_add_u32 s80, s80, s83
  buffer_load_dwordx4 v[108:111], v161, s[52:55], s80 offen nt
  s_add_u32 s80, s80, s81
ND_21:
  s_cmp_eq_u32 s91, 2
  s_cbranch_scc1 WA_22
  s_cmp_eq_u32 s91, 1
  s_cbranch_scc1 WB_23
  s_waitcnt vmcnt(0)
  s_branch WC_24
WB_23:
  s_waitcnt vmcnt(4)
  s_branch WC_24
WA_22:
  s_waitcnt vmcnt(7)
WC_24:
  v_dot2_f32_bf16 v152, v48, v4, 0
  v_dot2_f32_bf16 v153, v52, v8, 0
  v_dot2_f32_bf16 v154, v56, v12, 0
  v_dot2_f32_bf16 v152, v49, v5, v152
  v_dot2_f32_bf16 v153, v53, v9, v153
  v_dot2_f32_bf16 v154, v57, v13, v154
  v_dot2_f32_bf16 v152, v50, v6, v152
  v_dot2_f32_bf16 v153, v54, v10, v153
  v_dot2_f32_bf16 v154, v58, v14, v154
  v_dot2_f32_bf16 v152, v51, v7, v152
  v_dot2_f32_bf16 v153, v55, v11, v153
  v_dot2_f32_bf16 v154, v59, v15, v154
  s_nop 1
  v_add_f32 v152, v152, v153
L_pad_38:
  s_cbranch_execz L_pad_39
  v_add_f32 v152, v152, v154
  s_nop 1
  v_add_f32_dpp v152, v152, v152 quad_perm:[1,0,3,2] row_mask:0xf bank_mask:0xf
  s_nop 1
  v_add_f32_dpp v152, v152, v152 quad_perm:[2,3,0,1] row_mask:0xf bank_mask:0xf
  s_nop 1
  v_add_f32_dpp v152, v152, v152 row_half_mirror row_mask:0xf bank_mask:0xf
  v_cvt_pk_bf16_f32 v152, v152, v152
  v_lshlrev_b32 v152, 16, v152
  v_mul_f32 v152, 0x3d93cd3a, v152
  v_cvt_pk_bf16_f32 v152, v152, v152
  v_lshlrev_b32 v152, 16, v152
  v_max_f32 v155, v152, v164
  s_nop 1
  v_max_f32_dpp v155, v155, v155 row_ror:8 row_mask:0xf bank_mask:0xf
  v_mov_b32 v157, v155
  s_nop 1
  v_permlane16_swap_b32 v157, v155
  v_max_f32 v155, v157, v155
  v_mov_b32 v157, v155
  s_nop 1
  v_permlane32_swap_b32 v157, v155
  v_max_f32 v155, v157, v155
  v_sub_f32 v156, v164, v155
  v_sub_f32 v152, v152, v155
  v_mul_f32 v156, 0x3fb8aa3b, v156
L_pad_39:
  s_cbranch_execz L_pad_40
  v_mul_f32 v152, 0x3fb8aa3b, v152
  v_exp_f32 v156, v156
  v_exp_f32 v152, v152
  v_mov_b32 v164, v155
  v_cvt_pk_bf16_f32 v153, v152, 0
  v_lshlrev_b32 v154, 16, v153
  v_mul_f32 v24, v24, v156
  v_mul_f32 v25, v25, v156
  v_mul_f32 v26, v26, v156
  v_mul_f32 v27, v27, v156
  v_mul_f32 v28, v28, v156
  v_mul_f32 v29, v29, v156
  v_mul_f32 v30, v30, v156
  v_mul_f32 v31, v31, v156
  v_mul_f32 v32, v32, v156
  v_mul_f32 v33, v33, v156
  v_mul_f32 v34, v34, v156
  v_mul_f32 v35, v35, v156
  v_mul_f32 v36, v36, v156
  v_mul_f32 v37, v37, v156
  v_mul_f32 v38, v38, v156
  v_mul_f32 v39, v39, v156
  v_mul_f32 v40, v40, v156
L_pad_40:
  s_cbranch_execz L_pad_41
  v_mul_f32 v41, v41, v156
  v_mul_f32 v42, v42, v156
  v_mul_f32 v43, v43, v156
  v_mul_f32 v44, v44, v156
  v_mul_f32 v45, v45, v156
  v_mul_f32 v46, v46, v156
  v_mul_f32 v47, v47, v156
  v_add_f32_dpp v152, v152, v152 row_ror:8 row_mask:0xf bank_mask:0xf
  v_mov_b32 v157, v152
  s_nop 1
  v_permlane16_swap_b32 v157, v152
  v_add_f32 v152, v157, v152
  v_mov_b32 v157, v152
  s_nop 1
  v_permlane32_swap_b32 v157, v152
  v_add_f32 v152, v157, v152
  v_fma_f32 v165, v165, v156, v152
  v_dot2_f32_bf16 v24, v60, v153, v24
  v_dot2_f32_bf16 v25, v60, v154, v25
  v_dot2_f32_bf16 v26, v61, v153, v26
  v_dot2_f32_bf16 v27, v61, v154, v27
  v_dot2_f32_bf16 v28, v62, v153, v28
  v_dot2_f32_bf16 v29, v62, v154, v29
  v_dot2_f32_bf16 v30, v63, v153, v30
L_pad_41:
  s_cbranch_execz L_pad_42
  v_dot2_f32_bf16 v31, v63, v154, v31
  v_dot2_f32_bf16 v32, v64, v153, v32
  v_dot2_f32_bf16 v33, v64, v154, v33
  v_dot2_f32_bf16 v34, v65, v153, v34
  v_dot2_f32_bf16 v35, v65, v154, v35
  v_dot2_f32_bf16 v36, v66, v153, v36
  v_dot2_f32_bf16 v37, v66, v154, v37
  v_dot2_f32_bf16 v38, v67, v153, v38
  v_dot2_f32_bf16 v39, v67, v154, v39
  v_dot2_f32_bf16 v40, v68, v153, v40
  v_dot2_f32_bf16 v41, v68, v154, v41
  v_dot2_f32_bf16 v42, v69, v153, v42
  v_dot2_f32_bf16 v43, v69, v154, v43
  v_dot2_f32_bf16 v44, v70, v153, v44
  v_dot2_f32_bf16 v45, v70, v154, v45
  v_dot2_f32_bf16 v46, v71, v153, v46
  v_dot2_f32_bf16 v47, v71, v154, v47
  s_branch L_dyn0
L_dyn_end:
  s_lshl_b32 s71, s3, 3
  v_mov_b32 v154, s71
  ds_write_b64 v154, v[164:165] offset:64
  v_permlane32_swap_b32 v24, v28
  v_permlane32_swap_b32 v25, v29
  v_permlane32_swap_b32 v26, v30
L_pad_42:
  s_cbranch_execz L_pad_43
  v_permlane32_swap_b32 v27, v31
  v_permlane32_swap_b32 v32, v36
  v_permlane32_swap_b32 v33, v37
  v_permlane32_swap_b32 v34, v38
  v_permlane32_swap_b32 v35, v39
  v_permlane32_swap_b32 v40, v44
  v_permlane32_swap_b32 v41, v45
  v_permlane32_swap_b32 v42, v46
  v_permlane32_swap_b32 v43, v47
  v_add_f32 v24, v24, v28
  v_add_f32 v25, v25, v29
  v_add_f32 v26, v26, v30
  v_add_f32 v27, v27, v31
  v_add_f32 v32, v32, v36
  v_add_f32 v33, v33, v37
  v_add_f32 v34, v34, v38
  v_add_f32 v35, v35, v39
  v_add_f32 v40, v40, v44
  v_add_f32 v41, v41, v45
  v_add_f32 v42, v42, v46
  v_add_f32 v43, v43, v47
  v_permlane16_swap_b32 v24, v26
  v_permlane16_swap_b32 v25, v27
L_pad_43:
  s_cbranch_execz L_pad_44
  v_permlane16_swap_b32 v32, v34
  v_permlane16_swap_b32 v33, v35
  v_permlane16_swap_b32 v40, v42
  v_permlane16_swap_b32 v41, v43
  v_add_f32 v24, v24, v26
  v_add_f32 v25, v25, v27
  v_add_f32 v32, v32, v34
  v_add_f32 v33, v33, v35
  v_add_f32 v40, v40, v42
  v_add_f32 v41, v41, v43
  v_add_f32_dpp v24, v24, v24 row_ror:8 row_mask:0xf bank_mask:0xf
  v_add_f32_dpp v25, v25, v25 row_ror:8 row_mask:0xf bank_mask:0xf
  v_add_f32_dpp v32, v32, v32 row_ror:8 row_mask:0xf bank_mask:0xf
  v_add_f32_dpp v33, v33, v33 row_ror:8 row_mask:0xf bank_mask:0xf
  v_add_f32_dpp v40, v40, v40 row_ror:8 row_mask:0xf bank_mask:0xf
  v_add_f32_dpp v41, v41, v41 row_ror:8 row_mask:0xf bank_mask:0xf
  v_and_b32 v152, 7, v1
  v_lshlrev_b32 v152, 5, v152
  v_lshrrev_b32 v153, 5, v1
  v_lshl_add_u32 v152, v153, 4, v152
  v_bfe_u32 v153, v1, 4, 1
  v_lshl_add_u32 v152, v153, 3, v152
  s_mul_i32 s71, s3, 768
L_pad_44:
  s_cbranch_execz L_pad_45
  v_add_u32 v152, s71, v152
  ds_write_b64 v152, v[24:25] offset:9728
  ds_write_b64 v152, v[32:33] offset:9984
  ds_write_b64 v152, v[40:41] offset:10240
  v_and_b32 v153, 7, v1
  v_mul_u32_u24 v156, 12, v153
  v_lshrrev_b32 v157, 3, v1
  v_mul_u32_u24 v157, 768, v157
  v_add_u32 v156, v156, v157
  s_mul_i32 s70, s3, 96
  s_add_u32 s70, s70, 9728
  v_add_u32 v156, s70, v156
  v_lshlrev_b32 v153, 4, v153
  s_lshl_b32 s70, s6, 15
  s_lshl_b32 s71, s5, 10
  s_add_u32 s70, s70, s71
  s_lshl_b32 s71, s3, 7
  s_add_u32 s70, s70, s71
  s_add_u32 s70, s70, 655360
  v_lshrrev_b32 v157, 3, v1
  v_lshlrev_b32 v157, 3, v157
  s_lshl_b32 s74, s4, 4
  s_add_u32 s74, s74, 16384
L_pad_45:
  s_cbranch_execz L_pad_46
  s_cmp_eq_u32 s3, 0
  s_cselect_b32 s76, 1, 0
  s_mov_b32 s77, 0
  s_mov_b32 s72, 0xff
  s_mov_b32 s73, 0
  s_waitcnt lgkmcnt(0)
  s_barrier
  ds_read_b64 v[56:57], v157 offset:64
  ds_read2_b32 v[48:49], v156 offset0:0 offset1:1
  ds_read_b32 v50, v156 offset:8
  v_mov_b32 v51, s7
  v_mov_b32 v61, s7
  v_mov_b32 v63, s7
  s_waitcnt lgkmcnt(2)
  v_mov_b32 v60, v56
  s_nop 1
  v_max_f32_dpp v60, v60, v60 row_ror:8 row_mask:0xf bank_mask:0xf
  v_mov_b32 v52, v60
  s_nop 1
  v_permlane16_swap_b32 v52, v60
  v_max_f32 v60, v52, v60
  v_mov_b32 v52, v60
  s_nop 1
  v_permlane32_swap_b32 v52, v60
  v_max_f32 v60, v52, v60
  v_sub_f32 v56, v56, v60
L_pad_46:
  s_cbranch_execz L_pad_47
  v_mul_f32 v56, 0x3fb8aa3b, v56
  v_exp_f32 v56, v56
  s_waitcnt lgkmcnt(0)
  v_mul_f32 v48, v48, v56
  v_mul_f32 v49, v49, v56
  v_mul_f32 v50, v50, v56
  v_mul_f32 v62, v57, v56
  v_add_f32_dpp v48, v48, v48 row_ror:8 row_mask:0xf bank_mask:0xf
  v_add_f32_dpp v49, v49, v49 row_ror:8 row_mask:0xf bank_mask:0xf
  v_add_f32_dpp v50, v50, v50 row_ror:8 row_mask:0xf bank_mask:0xf
  v_add_f32_dpp v62, v62, v62 row_ror:8 row_mask:0xf bank_mask:0xf
  v_mov_b32 v52, v48
  v_mov_b32 v53, v49
  v_mov_b32 v54, v50
  v_mov_b32 v55, v62
  v_permlane16_swap_b32 v52, v48
  v_permlane16_swap_b32 v53, v49
  v_permlane16_swap_b32 v54, v50
  v_permlane16_swap_b32 v55, v62
  v_add_f32 v48, v52, v48
  v_add_f32 v49, v53, v49
  v_add_f32 v50, v54, v50
  v_add_f32 v62, v55, v62
  v_mov_b32 v52, v48
L_pad_47:
  s_cbranch_execz L_pad_48
  v_mov_b32 v53, v49
  v_mov_b32 v54, v50
  v_mov_b32 v55, v62
  v_permlane32_swap_b32 v52, v48
  v_permlane32_swap_b32 v53, v49
  v_permlane32_swap_b32 v54, v50
  v_permlane32_swap_b32 v55, v62
  v_add_f32 v48, v52, v48
  v_add_f32 v49, v53, v49
  v_add_f32 v50, v54, v50
  v_add_f32 v62, v55, v62
  s_mov_b64 exec, s[72:73]
  buffer_store_dwordx4 v[48:51], v153, s[64:67], s70 offen sc1
  s_mov_b64 exec, s[76:77]
  buffer_store_dwordx4 v[60:63], v3, s[64:67], s74 offen sc1
  s_mov_b64 exec, -1
  s_barrier
  s_cmp_ge_u32 s8, 160
  s_cbranch_scc1 L_nwo45
  buffer_load_dwordx4 v[112:115], v161, s[52:55], s80 offen nt
  s_add_u32 s80, s80, s81
  buffer_load_dwordx4 v[116:119], v161, s[52:55], s80 offen nt
  s_add_u32 s80, s80, s83
  s_branch L_wo
L_nwo45:
  s_cmp_ge_u32 s8, 228
L_pad_48:
  s_cbranch_execz L_pad_49
  s_cbranch_scc1 L_b_end0
  s_cmp_lt_u32 s8, 160
  s_cbranch_scc1 L_wo
  s_cmp_lg_u32 s87, 0
  s_cbranch_scc1 L_t4
  buffer_load_dwordx4 v[96:99], v161, s[52:55], s80 offen nt
  s_add_u32 s80, s80, s81
  buffer_load_dwordx4 v[100:103], v161, s[52:55], s80 offen nt
  s_add_u32 s80, s80, s81
  buffer_load_dwordx4 v[104:107], v161, s[52:55], s80 offen nt
  s_add_u32 s80, s80, s81
  buffer_load_dwordx4 v[108:111], v161, s[52:55], s80 offen nt
  s_add_u32 s80, s80, s81
L_t4:
  buffer_load_dwordx4 v[112:115], v161, s[52:55], s80 offen nt
  s_add_u32 s80, s80, s81
  buffer_load_dwordx4 v[116:119], v161, s[52:55], s80 offen nt
  s_add_u32 s80, s80, s81
  s_waitcnt vmcnt(5)
  buffer_load_dwordx4 v[120:123], v161, s[52:55], s80 offen nt
  s_add_u32 s80, s80, s81
  s_waitcnt vmcnt(5)
  buffer_load_dwordx4 v[124:127], v161, s[52:55], s80 offen nt
  s_add_u32 s80, s80, s81
  s_waitcnt vmcnt(5)
  buffer_load_dwordx4 v[128:131], v161, s[52:55], s80 offen nt
  s_add_u32 s80, s80, s81
L_pad_49:
  s_cbranch_execz L_pad_50
  s_waitcnt vmcnt(5)
  buffer_load_dwordx4 v[132:135], v161, s[52:55], s80 offen nt
  s_add_u32 s80, s80, s81
  s_cmp_lt_u32 s8, 208
  s_cbranch_scc1 L_gu
  s_waitcnt vmcnt(5)
  buffer_load_dwordx4 v[136:139], v161, s[52:55], s80 offen nt
  s_add_u32 s80, s80, s81
  s_waitcnt vmcnt(5)
  buffer_load_dwordx4 v[140:143], v161, s[52:55], s80 offen nt
  s_add_u32 s80, s80, s81
  s_branch L_dn
L_b_end0:
L_pad_50:
  s_cbranch_execz L_ch_bulk_ret
L_b_end:
  s_endpgm
L_wo:
L_ch_wo:
L_pad_51:
  s_cbranch_execz L_pad_52
  v_and_b32 v158, 7, v1
  v_lshlrev_b32 v154, 15, v158
  v_lshrrev_b32 v155, 3, v1
  v_lshl_add_u32 v154, v155, 4, v154
  v_lshlrev_b32 v158, 4, v158
  s_lshl_b32 s72, s9, 1
  s_lshr_b32 s73, s3, 2
  s_add_u32 s72, s72, s73
  s_lshl_b32 s71, s72, 10
  s_and_b32 s73, s3, 3
  s_lshl_b32 s73, s73, 8
  s_add_u32 s71, s71, s73
  s_add_u32 s71, s71, 655360
  s_lshl_b32 s73, s72, 7
  s_add_u32 s73, s73, 16384
  v_and_b32 v155, 7, v1
  v_lshlrev_b32 v155, 5, v155
  v_lshrrev_b32 v157, 5, v1
  v_lshl_add_u32 v155, v157, 4, v155
  v_bfe_u32 v157, v1, 4, 1
  v_lshl_add_u32 v155, v157, 3, v155
  v_bfe_u32 v157, v1, 3, 1
  v_lshl_add_u32 v155, v157, 2, v155
L_pad_52:
  s_cbranch_execz L_pad_53
  s_lshl_b32 s72, s3, 8
  v_add_u32 v155, s72, v155
  s_mov_b32 s90, 0
PLo_25:
  buffer_load_dwordx4 v[48:51], v154, s[64:67], s71 offen offset:0 sc1
  buffer_load_dwordx4 v[52:55], v154, s[64:67], s71 offen offset:128 sc1
  buffer_load_dwordx4 v[56:59], v158, s[64:67], s73 offen sc1
  s_waitcnt vmcnt(0)
  v_cmp_ne_u32 s[92:93], s7, v51
  v_cmp_ne_u32 vcc, s7, v55
  s_or_b64 s[92:93], s[92:93], vcc
  v_cmp_ne_u32 vcc, s7, v57
  s_or_b64 s[92:93], s[92:93], vcc
  v_cmp_ne_u32 vcc, s7, v59
  s_or_b64 s[92:93], s[92:93], vcc
  s_cmp_eq_u64 s[92:93], 0
  s_cbranch_scc1 PDo_26
  s_add_u32 s90, s90, 1
  s_cmp_lt_u32 s90, 65536
  s_cbranch_scc1 PLo_25
PDo_26:
  v_mov_b32 v68, v56
  s_nop 1
  v_max_f32_dpp v68, v68, v68 quad_perm:[1,0,3,2] row_mask:0xf bank_mask:0xf
  s_nop 1
  v_max_f32_dpp v68, v68, v68 quad_perm:[2,3,0,1] row_mask:0xf bank_mask:0xf
  s_nop 1
  v_max_f32_dpp v68, v68, v68 row_half_mirror row_mask:0xf bank_mask:0xf
L_pad_53:
  s_cbranch_execz L_pad_54
  v_sub_f32 v68, v56, v68
  v_mul_f32 v68, 0x3fb8aa3b, v68
  v_exp_f32 v68, v68
  s_nop 0
  v_mul_f32 v69, v58, v68
  s_nop 1
  v_add_f32_dpp v69, v69, v69 quad_perm:[1,0,3,2] row_mask:0xf bank_mask:0xf
  s_nop 1
  v_add_f32_dpp v69, v69, v69 quad_perm:[2,3,0,1] row_mask:0xf bank_mask:0xf
  s_nop 1
  v_add_f32_dpp v69, v69, v69 row_half_mirror row_mask:0xf bank_mask:0xf
  v_rcp_f32 v69, v69
  s_nop 0
  v_mul_f32 v68, v68, v69
  v_mul_f32 v48, v48, v68
  v_mul_f32 v49, v49, v68
  v_mul_f32 v50, v50, v68
  v_mul_f32 v52, v52, v68
  v_mul_f32 v53, v53, v68
  v_mul_f32 v54, v54, v68
  v_add_f32_dpp v48, v48, v48 quad_perm:[1,0,3,2] row_mask:0xf bank_mask:0xf
  v_add_f32_dpp v49, v49, v49 quad_perm:[1,0,3,2] row_mask:0xf bank_mask:0xf
  v_add_f32_dpp v50, v50, v50 quad_perm:[1,0,3,2] row_mask:0xf bank_mask:0xf
  v_add_f32_dpp v52, v52, v52 quad_perm:[1,0,3,2] row_mask:0xf bank_mask:0xf
  v_add_f32_dpp v53, v53, v53 quad_perm:[1,0,3,2] row_mask:0xf bank_mask:0xf
  v_add_f32_dpp v54, v54, v54 quad_perm:[1,0,3,2] row_mask:0xf bank_mask:0xf
L_pad_54:
  s_cbranch_execz L_pad_55
  v_add_f32_dpp v48, v48, v48 quad_perm:[2,3,0,1] row_mask:0xf bank_mask:0xf
  v_add_f32_dpp v49, v49, v49 quad_perm:[2,3,0,1] row_mask:0xf bank_mask:0xf
  v_add_f32_dpp v50, v50, v50 quad_perm:[2,3,0,1] row_mask:0xf bank_mask:0xf
  v_add_f32_dpp v52, v52, v52 quad_perm:[2,3,0,1] row_mask:0xf bank_mask:0xf
  v_add_f32_dpp v53, v53, v53 quad_perm:[2,3,0,1] row_mask:0xf bank_mask:0xf
  v_add_f32_dpp v54, v54, v54 quad_perm:[2,3,0,1] row_mask:0xf bank_mask:0xf
  v_add_f32_dpp v48, v48, v48 row_half_mirror row_mask:0xf bank_mask:0xf
  v_add_f32_dpp v49, v49, v49 row_half_mirror row_mask:0xf bank_mask:0xf
  v_add_f32_dpp v50, v50, v50 row_half_mirror row_mask:0xf bank_mask:0xf
  v_add_f32_dpp v52, v52, v52 row_half_mirror row_mask:0xf bank_mask:0xf
  v_add_f32_dpp v53, v53, v53 row_half_mirror row_mask:0xf bank_mask:0xf
  v_add_f32_dpp v54, v54, v54 row_half_mirror row_mask:0xf bank_mask:0xf
  v_cvt_pk_bf16_f32 v72, v48, 0
  v_cvt_pk_bf16_f32 v74, v49, 0
  v_cvt_pk_bf16_f32 v76, v50, 0
  v_cvt_pk_bf16_f32 v78, v52, 0
  v_cvt_pk_bf16_f32 v80, v53, 0
  v_cvt_pk_bf16_f32 v82, v54, 0
  v_lshlrev_b32 v73, 16, v72
  v_lshlrev_b32 v75, 16, v74
  v_lshlrev_b32 v77, 16, v76
  v_lshlrev_b32 v79, 16, v78
  v_lshlrev_b32 v81, 16, v80
L_pad_55:
  s_cbranch_execz L_pad_56
  v_lshlrev_b32 v83, 16, v82
  v_dot2_f32_bf16 v60, v96, v72, 0
  v_dot2_f32_bf16 v61, v96, v73, 0
  v_dot2_f32_bf16 v62, v97, v72, 0
  v_dot2_f32_bf16 v63, v97, v73, 0
  v_dot2_f32_bf16 v64, v98, v72, 0
  v_dot2_f32_bf16 v65, v98, v73, 0
  v_dot2_f32_bf16 v66, v99, v72, 0
  v_dot2_f32_bf16 v67, v99, v73, 0
  v_dot2_f32_bf16 v60, v100, v74, v60
  v_dot2_f32_bf16 v61, v100, v75, v61
  v_dot2_f32_bf16 v62, v101, v74, v62
  v_dot2_f32_bf16 v63, v101, v75, v63
  v_dot2_f32_bf16 v64, v102, v74, v64
  v_dot2_f32_bf16 v65, v102, v75, v65
  v_dot2_f32_bf16 v66, v103, v74, v66
  v_dot2_f32_bf16 v67, v103, v75, v67
  v_dot2_f32_bf16 v60, v104, v76, v60
  v_dot2_f32_bf16 v61, v104, v77, v61
  v_dot2_f32_bf16 v62, v105, v76, v62
  v_dot2_f32_bf16 v63, v105, v77, v63
  v_dot2_f32_bf16 v64, v106, v76, v64
  v_dot2_f32_bf16 v65, v106, v77, v65
L_pad_56:
  s_cbranch_execz L_pad_57
  v_dot2_f32_bf16 v66, v107, v76, v66
  v_dot2_f32_bf16 v67, v107, v77, v67
  v_dot2_f32_bf16 v60, v108, v78, v60
  v_dot2_f32_bf16 v61, v108, v79, v61
  v_dot2_f32_bf16 v62, v109, v78, v62
  v_dot2_f32_bf16 v63, v109, v79, v63
  v_dot2_f32_bf16 v64, v110, v78, v64
  v_dot2_f32_bf16 v65, v110, v79, v65
  v_dot2_f32_bf16 v66, v111, v78, v66
  v_dot2_f32_bf16 v67, v111, v79, v67
  v_dot2_f32_bf16 v60, v112, v80, v60
  v_dot2_f32_bf16 v61, v112, v81, v61
  v_dot2_f32_bf16 v62, v113, v80, v62
  v_dot2_f32_bf16 v63, v113, v81, v63
  v_dot2_f32_bf16 v64, v114, v80, v64
  v_dot2_f32_bf16 v65, v114, v81, v65
  v_dot2_f32_bf16 v66, v115, v80, v66
  v_dot2_f32_bf16 v67, v115, v81, v67
  v_dot2_f32_bf16 v60, v116, v82, v60
  v_dot2_f32_bf16 v61, v116, v83, v61
  v_dot2_f32_bf16 v62, v117, v82, v62
  v_dot2_f32_bf16 v63, v117, v83, v63
  v_dot2_f32_bf16 v64, v118, v82, v64
L_pad_57:
  s_cbranch_execz L_pad_58
  v_dot2_f32_bf16 v65, v118, v83, v65
  v_dot2_f32_bf16 v66, v119, v82, v66
  v_dot2_f32_bf16 v67, v119, v83, v67
  v_permlane32_swap_b32 v60, v64
  v_permlane32_swap_b32 v61, v65
  v_permlane32_swap_b32 v62, v66
  v_permlane32_swap_b32 v63, v67
  v_add_f32 v60, v60, v64
  v_add_f32 v61, v61, v65
  v_add_f32 v62, v62, v66
  v_add_f32 v63, v63, v67
  s_nop 0
  v_permlane16_swap_b32 v60, v62
  v_permlane16_swap_b32 v61, v63
  v_add_f32 v60, v60, v62
  v_add_f32 v61, v61, v63
  s_nop 0
  v_add_f32_dpp v60, v60, v60 row_ror:8 row_mask:0xf bank_mask:0xf
  v_add_f32_dpp v61, v61, v61 row_ror:8 row_mask:0xf bank_mask:0xf
  v_cndmask_b32 v60, v60, v61, s[68:69]
  ds_write_b32 v155, v60 offset:16384
  s_waitcnt lgkmcnt(0)
  s_barrier
  s_cmp_eq_u32 s3, 1
  s_cbranch_scc1 L_b_own
  s_cmp_lg_u32 s3, 0
L_pad_58:
  s_cbranch_execz L_pad_59
  s_cbranch_scc1 L_wo_end
  v_lshlrev_b32 v152, 2, v1
  ds_read_b32 v48, v152 offset:16384
  ds_read_b32 v49, v152 offset:16640
  ds_read_b32 v50, v152 offset:16896
  ds_read_b32 v51, v152 offset:17152
  ds_read_b32 v52, v152 offset:17408
  ds_read_b32 v53, v152 offset:17664
  ds_read_b32 v54, v152 offset:17920
  ds_read_b32 v55, v152 offset:18176
  v_lshrrev_b32 v153, 3, v1
  v_lshlrev_b32 v153, 10, v153
  v_and_b32 v154, 7, v1
  v_lshl_add_u32 v153, v154, 3, v153
  s_lshl_b32 s70, s10, 13
  s_lshl_b32 s71, s9, 6
  s_add_u32 s70, s70, s71
  s_add_u32 s70, s70, 49152
  s_waitcnt lgkmcnt(0)
  v_add_f32 v48, v48, v49
  v_add_f32 v48, v48, v50
  v_add_f32 v48, v48, v51
  v_add_f32 v48, v48, v52
  v_add_f32 v48, v48, v53
L_pad_59:
  s_cbranch_execz L_pad_60
  v_add_f32 v48, v48, v54
  v_add_f32 v48, v48, v55
  v_mov_b32 v49, s7
  buffer_store_dwordx2 v[48:49], v153, s[64:67], s70 offen sc1
  s_branch L_wo_end
L_b_own:
  s_cmp_ge_u32 s8, 80
  s_cbranch_scc1 L_wo_end
  v_lshlrev_b32 v152, 3, v1
  s_lshl_b32 s70, s8, 10
  s_add_u32 s70, s70, 49152
  v_and_b32 v153, 7, v1
  v_lshlrev_b32 v154, 2, v153
  ds_read_b32 v156, v154 offset:192
  ds_read_b32 v157, v154 offset:224
  v_lshrrev_b32 v155, 3, v1
  v_mul_u32_u24 v155, 2560, v155
  v_lshrrev_b32 v153, 1, v153
  v_lshl_add_u32 v155, v153, 3, v155
  s_lshl_b32 s71, s8, 5
  s_add_u32 s71, s71, 20480
  s_mov_b32 s72, 0x55555555
  s_mov_b32 s73, 0x55555555
  s_mov_b32 s90, 0
PLa_27:
  buffer_load_dwordx2 v[48:49], v152, s[64:67], s70 offen offset:0 sc1
L_pad_60:
  s_cbranch_execz L_pad_61
  buffer_load_dwordx2 v[50:51], v152, s[64:67], s70 offen offset:512 sc1
  s_waitcnt vmcnt(0)
  v_cmp_ne_u32 s[92:93], s7, v49
  v_cmp_ne_u32 vcc, s7, v51
  s_or_b64 s[92:93], s[92:93], vcc
  s_cmp_eq_u64 s[92:93], 0
  s_cbranch_scc1 PDa_28
  s_add_u32 s90, s90, 1
  s_cmp_lt_u32 s90, 65536
  s_cbranch_scc1 PLa_27
PDa_28:
  s_waitcnt lgkmcnt(0)
  v_add_f32 v48, v48, v50
  s_nop 1
  v_add_f32_dpp v48, v48, v48 row_ror:8 row_mask:0xf bank_mask:0xf
  v_mov_b32 v158, v48
  s_nop 1
  v_permlane16_swap_b32 v158, v48
  v_add_f32 v48, v158, v48
  v_mov_b32 v158, v48
  s_nop 1
  v_permlane32_swap_b32 v158, v48
  v_add_f32 v48, v158, v48
  v_cvt_pk_bf16_f32 v48, v48, v48
  v_lshlrev_b32 v48, 16, v48
  v_mul_f32 v48, v48, v156
  v_cvt_pk_bf16_f32 v48, v48, v48
  v_lshlrev_b32 v48, 16, v48
L_pad_61:
  s_cbranch_execz L_pad_62
  v_add_f32 v48, v48, v157
  v_cvt_pk_bf16_f32 v48, v48, v48
  v_lshlrev_b32 v48, 16, v48
  s_nop 1
  v_mov_b32_dpp v157, v48 quad_perm:[1,0,3,2] row_mask:0xf bank_mask:0xf
  v_lshrrev_b32 v48, 16, v48
  v_or_b32 v48, v48, v157
  v_mov_b32 v49, s7
  s_mov_b64 exec, s[72:73]
  buffer_store_dwordx2 v[48:49], v155, s[64:67], s71 offen sc1
  s_mov_b64 exec, -1
L_wo_end:
L_pad_62:
  s_cbranch_execz L_ch_wo_ret
  s_branch L_b_end
L_gu:
L_ch_gu:
L_pad_63:
  s_cbranch_execz L_pad_64
  s_sub_u32 s74, s8, 160
  s_and_b32 s75, s74, 1
  s_mul_i32 s70, s3, 640
  v_lshrrev_b32 v153, 3, v1
  v_lshlrev_b32 v153, 3, v153
  v_add_u32 v153, s70, v153
  v_and_b32 v154, 7, v1
  v_lshlrev_b32 v154, 5, v154
  v_lshrrev_b32 v155, 5, v1
  v_lshl_add_u32 v154, v155, 4, v154
  v_bfe_u32 v155, v1, 4, 1
  v_lshl_add_u32 v154, v155, 3, v154
  v_bfe_u32 v155, v1, 3, 1
  v_lshl_add_u32 v154, v155, 2, v154
  s_lshl_b32 s70, s3, 8
  v_add_u32 v154, s70, v154
  v_lshlrev_b32 v152, 3, v1
  v_lshlrev_b32 v155, 2, v1
  s_lshr_b32 s71, s74, 1
  s_lshl_b32 s70, s71, 9
  s_lshl_b32 s71, s75, 3
  s_add_u32 s70, s70, s71
  s_add_u32 s70, s70, 917504
L_pad_64:
  s_cbranch_execz L_pad_65
  s_mov_b32 s72, 0x55555555
  s_mov_b32 s73, 0x55555555
  s_add_u32 s76, s70, 16384
  s_add_u32 s77, s70, 32768
  s_add_u32 s78, s70, 49152
  s_waitcnt vmcnt(0)
  s_barrier
  ds_read_b64 v[48:49], v153 offset:20480
  ds_read_b64 v[50:51], v153 offset:20544
  ds_read_b64 v[52:53], v153 offset:20608
  ds_read_b64 v[54:55], v153 offset:20672
  ds_read_b64 v[56:57], v153 offset:20736
  ds_read_b64 v[58:59], v153 offset:20800
  ds_read_b64 v[60:61], v153 offset:20864
  ds_read_b64 v[62:63], v153 offset:20928
  ds_read_b64 v[64:65], v153 offset:20992
  ds_read_b64 v[66:67], v153 offset:21056
  s_waitcnt lgkmcnt(5)
  v_dot2_f32_bf16 v72, v96, v48, 0
  v_dot2_f32_bf16 v73, v96, v49, 0
  v_dot2_f32_bf16 v74, v97, v48, 0
  v_dot2_f32_bf16 v75, v97, v49, 0
  v_dot2_f32_bf16 v76, v98, v48, 0
  v_dot2_f32_bf16 v77, v98, v49, 0
  v_dot2_f32_bf16 v78, v99, v48, 0
L_pad_65:
  s_cbranch_execz L_pad_66
  v_dot2_f32_bf16 v79, v99, v49, 0
  v_dot2_f32_bf16 v72, v100, v50, v72
  v_dot2_f32_bf16 v73, v100, v51, v73
  v_dot2_f32_bf16 v74, v101, v50, v74
  v_dot2_f32_bf16 v75, v101, v51, v75
  v_dot2_f32_bf16 v76, v102, v50, v76
  v_dot2_f32_bf16 v77, v102, v51, v77
  v_dot2_f32_bf16 v78, v103, v50, v78
  v_dot2_f32_bf16 v79, v103, v51, v79
  v_dot2_f32_bf16 v72, v104, v52, v72
  v_dot2_f32_bf16 v73, v104, v53, v73
  v_dot2_f32_bf16 v74, v105, v52, v74
  v_dot2_f32_bf16 v75, v105, v53, v75
  v_dot2_f32_bf16 v76, v106, v52, v76
  v_dot2_f32_bf16 v77, v106, v53, v77
  v_dot2_f32_bf16 v78, v107, v52, v78
  v_dot2_f32_bf16 v79, v107, v53, v79
  v_dot2_f32_bf16 v72, v108, v54, v72
  v_dot2_f32_bf16 v73, v108, v55, v73
  v_dot2_f32_bf16 v74, v109, v54, v74
  v_dot2_f32_bf16 v75, v109, v55, v75
  v_dot2_f32_bf16 v76, v110, v54, v76
  v_dot2_f32_bf16 v77, v110, v55, v77
L_pad_66:
  s_cbranch_execz L_pad_67
  v_dot2_f32_bf16 v78, v111, v54, v78
  v_dot2_f32_bf16 v79, v111, v55, v79
  v_dot2_f32_bf16 v72, v112, v56, v72
  v_dot2_f32_bf16 v73, v112, v57, v73
  v_dot2_f32_bf16 v74, v113, v56, v74
  v_dot2_f32_bf16 v75, v113, v57, v75
  v_dot2_f32_bf16 v76, v114, v56, v76
  v_dot2_f32_bf16 v77, v114, v57, v77
  v_dot2_f32_bf16 v78, v115, v56, v78
  v_dot2_f32_bf16 v79, v115, v57, v79
  s_waitcnt lgkmcnt(0)
  v_dot2_f32_bf16 v72, v116, v58, v72
  v_dot2_f32_bf16 v73, v116, v59, v73
  v_dot2_f32_bf16 v74, v117, v58, v74
  v_dot2_f32_bf16 v75, v117, v59, v75
  v_dot2_f32_bf16 v76, v118, v58, v76
  v_dot2_f32_bf16 v77, v118, v59, v77
  v_dot2_f32_bf16 v78, v119, v58, v78
  v_dot2_f32_bf16 v79, v119, v59, v79
  v_dot2_f32_bf16 v72, v120, v60, v72
  v_dot2_f32_bf16 v73, v120, v61, v73
  v_dot2_f32_bf16 v74, v121, v60, v74
  v_dot2_f32_bf16 v75, v121, v61, v75
  v_dot2_f32_bf16 v76, v122, v60, v76
L_pad_67:
  s_cbranch_execz L_pad_68
  v_dot2_f32_bf16 v77, v122, v61, v77
  v_dot2_f32_bf16 v78, v123, v60, v78
  v_dot2_f32_bf16 v79, v123, v61, v79
  v_dot2_f32_bf16 v72, v124, v62, v72
  v_dot2_f32_bf16 v73, v124, v63, v73
  v_dot2_f32_bf16 v74, v125, v62, v74
  v_dot2_f32_bf16 v75, v125, v63, v75
  v_dot2_f32_bf16 v76, v126, v62, v76
  v_dot2_f32_bf16 v77, v126, v63, v77
  v_dot2_f32_bf16 v78, v127, v62, v78
  v_dot2_f32_bf16 v79, v127, v63, v79
  v_dot2_f32_bf16 v72, v128, v64, v72
  v_dot2_f32_bf16 v73, v128, v65, v73
  v_dot2_f32_bf16 v74, v129, v64, v74
  v_dot2_f32_bf16 v75, v129, v65, v75
  v_dot2_f32_bf16 v76, v130, v64, v76
  v_dot2_f32_bf16 v77, v130, v65, v77
  v_dot2_f32_bf16 v78, v131, v64, v78
  v_dot2_f32_bf16 v79, v131, v65, v79
  v_dot2_f32_bf16 v72, v132, v66, v72
  v_dot2_f32_bf16 v73, v132, v67, v73
  v_dot2_f32_bf16 v74, v133, v66, v74
  v_dot2_f32_bf16 v75, v133, v67, v75
L_pad_68:
  s_cbranch_execz L_pad_69
  v_dot2_f32_bf16 v76, v134, v66, v76
  v_dot2_f32_bf16 v77, v134, v67, v77
  v_dot2_f32_bf16 v78, v135, v66, v78
  v_dot2_f32_bf16 v79, v135, v67, v79
  v_permlane32_swap_b32 v72, v76
  v_permlane32_swap_b32 v73, v77
  v_permlane32_swap_b32 v74, v78
  v_permlane32_swap_b32 v75, v79
  v_add_f32 v72, v72, v76
  v_add_f32 v73, v73, v77
  v_add_f32 v74, v74, v78
  v_add_f32 v75, v75, v79
  s_nop 0
  v_permlane16_swap_b32 v72, v74
  v_permlane16_swap_b32 v73, v75
  v_add_f32 v72, v72, v74
  v_add_f32 v73, v73, v75
  s_nop 0
  v_add_f32_dpp v72, v72, v72 row_ror:8 row_mask:0xf bank_mask:0xf
  v_add_f32_dpp v73, v73, v73 row_ror:8 row_mask:0xf bank_mask:0xf
  v_cndmask_b32 v72, v72, v73, s[68:69]
  ds_write_b32 v154, v72 offset:16384
  s_waitcnt lgkmcnt(0)
  s_barrier
  s_cmp_lg_u32 s3, 0
L_pad_69:
  s_cbranch_execz L_pad_70
  s_cbranch_scc1 L_gu_end
  ds_read_b32 v48, v155 offset:16384
  ds_read_b32 v49, v155 offset:16640
  ds_read_b32 v50, v155 offset:16896
  ds_read_b32 v51, v155 offset:17152
  ds_read_b32 v52, v155 offset:17408
  ds_read_b32 v53, v155 offset:17664
  ds_read_b32 v54, v155 offset:17920
  ds_read_b32 v55, v155 offset:18176
  v_mov_b32 v59, s7
  s_waitcnt lgkmcnt(0)
  v_add_f32 v48, v48, v49
  v_add_f32 v50, v50, v51
  v_add_f32 v52, v52, v53
  v_add_f32 v54, v54, v55
  v_add_f32 v48, v48, v50
  v_add_f32 v52, v52, v54
  v_add_f32 v48, v48, v52
  s_nop 1
  v_mov_b32_dpp v49, v48 quad_perm:[1,0,3,2] row_mask:0xf bank_mask:0xf
  v_cvt_pk_bf16_f32 v58, v48, v49
  s_mov_b64 exec, s[72:73]
  buffer_store_dwordx2 v[58:59], v152, s[64:67], s70 offen sc1
  buffer_store_dwordx2 v[58:59], v152, s[64:67], s76 offen sc1
  buffer_store_dwordx2 v[58:59], v152, s[64:67], s77 offen sc1
  buffer_store_dwordx2 v[58:59], v152, s[64:67], s78 offen sc1
  s_mov_b64 exec, -1
L_gu_end:
L_pad_70:
  s_cbranch_execz L_ch_gu_ret
  s_branch L_b_end
L_dn:
L_ch_dn:
L_pad_71:
  s_cbranch_execz L_pad_72
  s_sub_u32 s74, s8, 208
  v_lshlrev_b32 v152, 4, v1
  s_mul_i32 s70, s3, 1536
  s_add_u32 s70, s70, 917504
  s_and_b32 s71, s74, 3
  s_lshl_b32 s71, s71, 14
  s_add_u32 s70, s70, s71
  s_mul_i32 s71, s3, 1536
  v_lshlrev_b32 v153, 4, v1
  v_add_u32 v153, s71, v153
  v_lshrrev_b32 v154, 2, v1
  v_lshlrev_b32 v154, 3, v154
  v_add_u32 v154, s71, v154
  v_and_b32 v159, 31, v1
  v_lshlrev_b32 v159, 4, v159
  v_add_u32 v159, 1024, v159
  v_and_b32 v155, 3, v1
  v_lshlrev_b32 v155, 5, v155
  v_lshrrev_b32 v156, 5, v1
  v_lshl_add_u32 v155, v156, 4, v155
  v_bfe_u32 v156, v1, 4, 1
  v_lshl_add_u32 v155, v156, 3, v155
  v_bfe_u32 v156, v1, 3, 1
L_pad_72:
  s_cbranch_execz L_pad_73
  v_lshl_add_u32 v155, v156, 2, v155
  v_bfe_u32 v156, v1, 2, 1
  v_lshl_add_u32 v155, v156, 7, v155
  s_lshl_b32 s72, s3, 8
  v_add_u32 v155, s72, v155
  s_cmp_lg_u32 s3, 0
  s_cbranch_scc1 L_dn_nox
  v_and_b32 v157, 31, v1
  v_lshlrev_b32 v158, 2, v157
  ds_read_b32 v164, v158 offset:192
  v_lshrrev_b32 v157, 1, v157
  v_lshlrev_b32 v157, 3, v157
  s_and_b32 s75, s8, 7
  s_mul_i32 s75, s75, 2560
  s_lshl_b32 s76, s74, 7
  s_add_u32 s75, s75, s76
  s_add_u32 s75, s75, 20480
  s_mov_b32 s90, 0
PLx2_29:
  buffer_load_dwordx2 v[4:5], v157, s[64:67], s75 offen sc1
  s_waitcnt vmcnt(0)
  v_cmp_ne_u32 s[92:93], s7, v5
  s_cmp_eq_u64 s[92:93], 0
  s_cbranch_scc1 PDx2_30
  s_sleep 4
  s_add_u32 s90, s90, 1
L_pad_73:
  s_cbranch_execz L_pad_74
  s_cmp_lt_u32 s90, 65536
  s_cbranch_scc1 PLx2_29
PDx2_30:
  v_lshlrev_b32 v6, 16, v4
  v_and_b32 v7, 0xffff0000, v4
  v_and_b32 v157, 1, v1
  v_cmp_eq_u32 vcc, 1, v157
  s_nop 1
  v_cndmask_b32 v165, v6, v7, vcc
L_dn_nox:
  s_mov_b32 s90, 0
PLhh_31:
  buffer_load_dwordx4 v[48:51], v152, s[64:67], s70 offen sc1
  buffer_load_dwordx4 v[52:55], v159, s[64:67], s70 offen sc1
  s_waitcnt vmcnt(0)
  v_cmp_ne_u32 s[92:93], s7, v49
  v_cmp_ne_u32 vcc, s7, v51
  s_or_b64 s[92:93], s[92:93], vcc
  v_cmp_ne_u32 vcc, s7, v53
  s_or_b64 s[92:93], s[92:93], vcc
  v_cmp_ne_u32 vcc, s7, v55
  s_or_b64 s[92:93], s[92:93], vcc
  s_cmp_eq_u64 s[92:93], 0
  s_cbranch_scc1 PDhh_32
  s_sleep 1
  s_add_u32 s90, s90, 1
  s_cmp_lt_u32 s90, 65536
  s_cbranch_scc1 PLhh_31
PDhh_32:
  v_lshlrev_b32 v56, 16, v48
L_pad_74:
  s_cbranch_execz L_pad_75
  v_and_b32 v57, 0xffff0000, v48
  v_lshlrev_b32 v58, 16, v50
  v_and_b32 v59, 0xffff0000, v50
  v_lshlrev_b32 v60, 16, v52
  v_and_b32 v61, 0xffff0000, v52
  v_lshlrev_b32 v62, 16, v54
  v_and_b32 v63, 0xffff0000, v54
  v_mul_f32 v56, v56, v58
  v_mul_f32 v57, v57, v59
  v_mul_f32 v60, v60, v62
  v_mul_f32 v61, v61, v63
  v_cvt_pk_bf16_f32 v64, v56, 0
  v_cvt_pk_bf16_f32 v66, v57, 0
  v_cvt_pk_bf16_f32 v68, v60, 0
  v_cvt_pk_bf16_f32 v70, v61, 0
  v_lshlrev_b32 v65, 16, v64
  v_lshlrev_b32 v67, 16, v66
  v_lshlrev_b32 v69, 16, v68
  v_lshlrev_b32 v71, 16, v70
  ds_write_b128 v153, v[64:67] offset:20480
  s_mov_b32 s72, -1
  s_mov_b32 s73, 0
  s_mov_b64 exec, s[72:73]
  ds_write_b128 v153, v[68:71] offset:21504
  s_mov_b64 exec, -1
L_pad_75:
  s_cbranch_execz L_pad_76
  s_mov_b32 s72, -1
  s_mov_b32 s73, 0
  s_waitcnt lgkmcnt(0)
  ds_read_b64 v[24:25], v154 offset:20480
  ds_read_b64 v[26:27], v154 offset:20608
  ds_read_b64 v[28:29], v154 offset:20736
  ds_read_b64 v[30:31], v154 offset:20864
  ds_read_b64 v[32:33], v154 offset:20992
  ds_read_b64 v[34:35], v154 offset:21120
  ds_read_b64 v[36:37], v154 offset:21248
  ds_read_b64 v[38:39], v154 offset:21376
  ds_read_b64 v[40:41], v154 offset:21504
  ds_read_b64 v[42:43], v154 offset:21632
  ds_read_b64 v[44:45], v154 offset:21760
  ds_read_b64 v[46:47], v154 offset:21888
  s_waitcnt lgkmcnt(8)
  v_dot2_f32_bf16 v72, v96, v24, 0
  v_dot2_f32_bf16 v73, v96, v25, 0
  v_dot2_f32_bf16 v74, v97, v24, 0
  v_dot2_f32_bf16 v75, v97, v25, 0
  v_dot2_f32_bf16 v76, v98, v24, 0
  v_dot2_f32_bf16 v77, v98, v25, 0
  v_dot2_f32_bf16 v78, v99, v24, 0
  v_dot2_f32_bf16 v79, v99, v25, 0
L_pad_76:
  s_cbranch_execz L_pad_77
  v_dot2_f32_bf16 v72, v100, v26, v72
  v_dot2_f32_bf16 v73, v100, v27, v73
  v_dot2_f32_bf16 v74, v101, v26, v74
  v_dot2_f32_bf16 v75, v101, v27, v75
  v_dot2_f32_bf16 v76, v102, v26, v76
  v_dot2_f32_bf16 v77, v102, v27, v77
  v_dot2_f32_bf16 v78, v103, v26, v78
  v_dot2_f32_bf16 v79, v103, v27, v79
  v_dot2_f32_bf16 v72, v104, v28, v72
  v_dot2_f32_bf16 v73, v104, v29, v73
  v_dot2_f32_bf16 v74, v105, v28, v74
  v_dot2_f32_bf16 v75, v105, v29, v75
  v_dot2_f32_bf16 v76, v106, v28, v76
  v_dot2_f32_bf16 v77, v106, v29, v77
  v_dot2_f32_bf16 v78, v107, v28, v78
  v_dot2_f32_bf16 v79, v107, v29, v79
  v_dot2_f32_bf16 v72, v108, v30, v72
  v_dot2_f32_bf16 v73, v108, v31, v73
  v_dot2_f32_bf16 v74, v109, v30, v74
  v_dot2_f32_bf16 v75, v109, v31, v75
  v_dot2_f32_bf16 v76, v110, v30, v76
  v_dot2_f32_bf16 v77, v110, v31, v77
  v_dot2_f32_bf16 v78, v111, v30, v78
L_pad_77:
  s_cbranch_execz L_pad_78
  v_dot2_f32_bf16 v79, v111, v31, v79
  s_waitcnt lgkmcnt(4)
  v_dot2_f32_bf16 v72, v112, v32, v72
  v_dot2_f32_bf16 v73, v112, v33, v73
  v_dot2_f32_bf16 v74, v113, v32, v74
  v_dot2_f32_bf16 v75, v113, v33, v75
  v_dot2_f32_bf16 v76, v114, v32, v76
  v_dot2_f32_bf16 v77, v114, v33, v77
  v_dot2_f32_bf16 v78, v115, v32, v78
  v_dot2_f32_bf16 v79, v115, v33, v79
  v_dot2_f32_bf16 v72, v116, v34, v72
  v_dot2_f32_bf16 v73, v116, v35, v73
  v_dot2_f32_bf16 v74, v117, v34, v74
  v_dot2_f32_bf16 v75, v117, v35, v75
  v_dot2_f32_bf16 v76, v118, v34, v76
  v_dot2_f32_bf16 v77, v118, v35, v77
  v_dot2_f32_bf16 v78, v119, v34, v78
  v_dot2_f32_bf16 v79, v119, v35, v79
  v_dot2_f32_bf16 v72, v120, v36, v72
  v_dot2_f32_bf16 v73, v120, v37, v73
  v_dot2_f32_bf16 v74, v121, v36, v74
  v_dot2_f32_bf16 v75, v121, v37, v75
  v_dot2_f32_bf16 v76, v122, v36, v76
  v_dot2_f32_bf16 v77, v122, v37, v77
L_pad_78:
  s_cbranch_execz L_pad_79
  v_dot2_f32_bf16 v78, v123, v36, v78
  v_dot2_f32_bf16 v79, v123, v37, v79
  v_dot2_f32_bf16 v72, v124, v38, v72
  v_dot2_f32_bf16 v73, v124, v39, v73
  v_dot2_f32_bf16 v74, v125, v38, v74
  v_dot2_f32_bf16 v75, v125, v39, v75
  v_dot2_f32_bf16 v76, v126, v38, v76
  v_dot2_f32_bf16 v77, v126, v39, v77
  v_dot2_f32_bf16 v78, v127, v38, v78
  v_dot2_f32_bf16 v79, v127, v39, v79
  s_waitcnt lgkmcnt(0)
  v_dot2_f32_bf16 v72, v128, v40, v72
  v_dot2_f32_bf16 v73, v128, v41, v73
  v_dot2_f32_bf16 v74, v129, v40, v74
  v_dot2_f32_bf16 v75, v129, v41, v75
  v_dot2_f32_bf16 v76, v130, v40, v76
  v_dot2_f32_bf16 v77, v130, v41, v77
  v_dot2_f32_bf16 v78, v131, v40, v78
  v_dot2_f32_bf16 v79, v131, v41, v79
  v_dot2_f32_bf16 v72, v132, v42, v72
  v_dot2_f32_bf16 v73, v132, v43, v73
  v_dot2_f32_bf16 v74, v133, v42, v74
  v_dot2_f32_bf16 v75, v133, v43, v75
  v_dot2_f32_bf16 v76, v134, v42, v76
L_pad_79:
  s_cbranch_execz L_pad_80
  v_dot2_f32_bf16 v77, v134, v43, v77
  v_dot2_f32_bf16 v78, v135, v42, v78
  v_dot2_f32_bf16 v79, v135, v43, v79
  v_dot2_f32_bf16 v72, v136, v44, v72
  v_dot2_f32_bf16 v73, v136, v45, v73
  v_dot2_f32_bf16 v74, v137, v44, v74
  v_dot2_f32_bf16 v75, v137, v45, v75
  v_dot2_f32_bf16 v76, v138, v44, v76
  v_dot2_f32_bf16 v77, v138, v45, v77
  v_dot2_f32_bf16 v78, v139, v44, v78
  v_dot2_f32_bf16 v79, v139, v45, v79
  v_dot2_f32_bf16 v72, v140, v46, v72
  v_dot2_f32_bf16 v73, v140, v47, v73
  v_dot2_f32_bf16 v74, v141, v46, v74
  v_dot2_f32_bf16 v75, v141, v47, v75
  v_dot2_f32_bf16 v76, v142, v46, v76
  v_dot2_f32_bf16 v77, v142, v47, v77
  v_dot2_f32_bf16 v78, v143, v46, v78
  v_dot2_f32_bf16 v79, v143, v47, v79
  v_permlane32_swap_b32 v72, v76
  v_permlane32_swap_b32 v73, v77
  v_permlane32_swap_b32 v74, v78
  v_permlane32_swap_b32 v75, v79
L_pad_80:
  s_cbranch_execz L_pad_81
  v_add_f32 v72, v72, v76
  v_add_f32 v73, v73, v77
  v_add_f32 v74, v74, v78
  v_add_f32 v75, v75, v79
  s_nop 0
  v_permlane16_swap_b32 v72, v74
  v_permlane16_swap_b32 v73, v75
  v_add_f32 v72, v72, v74
  v_add_f32 v73, v73, v75
  s_nop 0
  v_add_f32_dpp v72, v72, v72 row_ror:8 row_mask:0xf bank_mask:0xf
  v_add_f32_dpp v73, v73, v73 row_ror:8 row_mask:0xf bank_mask:0xf
  v_cndmask_b32 v72, v72, v73, s[68:69]
  ds_write_b32 v155, v72 offset:16384
  v_and_b32 v152, 31, v1
  v_lshlrev_b32 v153, 2, v152
  v_lshrrev_b32 v154, 5, v1
  v_lshl_add_u32 v153, v154, 10, v153
  s_mov_b32 s44, s38
  s_and_b32 s45, s39, 0xffff
  s_mov_b32 s46, 1280
  s_mov_b32 s47, 0x20000
  s_lshl_b32 s70, s74, 6
  v_lshlrev_b32 v152, 1, v152
L_pad_81:
  s_cbranch_execz L_pad_82
  s_waitcnt lgkmcnt(0)
  s_barrier
  s_cmp_lg_u32 s3, 0
  s_cbranch_scc1 L_dn_end
  ds_read_b32 v48, v153 offset:16384
  ds_read_b32 v49, v153 offset:16512
  ds_read_b32 v50, v153 offset:16640
  ds_read_b32 v51, v153 offset:16768
  ds_read_b32 v52, v153 offset:16896
  ds_read_b32 v53, v153 offset:17024
  ds_read_b32 v54, v153 offset:17152
  ds_read_b32 v55, v153 offset:17280
  s_waitcnt lgkmcnt(0)
  v_add_f32 v48, v48, v49
  v_add_f32 v50, v50, v51
  v_add_f32 v52, v52, v53
  v_add_f32 v54, v54, v55
  v_add_f32 v48, v48, v50
  v_add_f32 v52, v52, v54
  v_add_f32 v48, v48, v52
  v_mov_b32 v49, v48
  s_nop 1
  v_permlane32_swap_b32 v49, v48
  v_add_f32 v48, v48, v49
  v_cvt_pk_bf16_f32 v48, v48, v48
  v_lshlrev_b32 v48, 16, v48
L_pad_82:
  s_cbranch_execz L_pad_83
  v_mul_f32 v48, v48, v164
  v_cvt_pk_bf16_f32 v48, v48, v48
  v_lshlrev_b32 v48, 16, v48
  v_add_f32 v48, v48, v165
  v_cvt_pk_bf16_f32 v48, v48, v48
  s_mov_b64 exec, s[72:73]
  buffer_store_short v48, v152, s[44:47], s70 offen
  s_mov_b64 exec, -1
L_dn_end:
L_pad_83:
  s_cbranch_execz L_ch_dn_ret
  s_branch L_b_end
L_aux:
  s_sub_u32 s3, s3, 8
  v_mov_b32 v3, 0
  v_mov_b32 v2, 1
  v_lshlrev_b32 v138, 2, v1
  ds_write_b32 v138, v3
  s_waitcnt lgkmcnt(0)
  s_barrier
  s_mov_b32 s56, s40
  s_and_b32 s57, s41, 0xffff
  s_mov_b32 s58, 256
  s_mov_b32 s59, 0x20000
  s_mov_b32 s64, s42
  s_and_b32 s65, s43, 0xffff
  s_mov_b32 s66, 1966080
  s_mov_b32 s67, 0x20000
  s_lshl_b32 s70, s6, 2
  s_add_u32 s70, s70, s3
  s_cmp_lg_u32 s70, 0
  s_cbranch_scc1 L_a_noinit
  s_lshl_b32 s70, s5, 9
  v_mov_b32 v166, 0
  s_mov_b64 exec, 1
  buffer_atomic_swap v166, v3, s[64:67], s70 offen sc0 sc1
  s_mov_b64 exec, -1
L_a_noinit:
  s_lshl_b32 s70, s8, 2
  s_add_u32 s70, s70, s3
  s_cmp_lg_u32 s70, 2
  s_cbranch_scc1 L_a_nononce
  s_memrealtime s[70:71]
  s_waitcnt lgkmcnt(0)
  s_or_b32 s70, s70, 1
  v_mov_b32 v140, s70
  s_mov_b64 exec, 1
  buffer_store_dword v140, v3, s[56:59], 0 offen sc1
  s_mov_b64 exec, -1
L_a_nononce:
  v_lshrrev_b32 v136, 3, v1
  v_and_b32 v137, 7, v1
  v_lshlrev_b32 v137, 4, v137
  v_and_b32 v141, 15, v1
  v_lshlrev_b32 v141, 1, v141
  v_lshrrev_b32 v140, 5, v1
  v_add_u32 v141, v141, v140
  v_bfe_u32 v140, v1, 4, 1
  v_lshl_add_u32 v142, v140, 5, v141
  s_cmp_lg_u32 s3, 1
  s_cbranch_scc1 L_a_nox
  s_mov_b32 s48, s16
  s_and_b32 s49, s17, 0xffff
  s_mov_b32 s50, 1280
  s_mov_b32 s51, 0x20000
  v_lshlrev_b32 v140, 4, v1
  buffer_load_dwordx4 v[4:7], v140, s[48:51], 0 offen
  buffer_load_dword v8, v138, s[48:51], 0 offen offset:1024
  v_lshlrev_b32 v140, 1, v142
  v_lshlrev_b32 v143, 1, v141
  s_mul_i32 s70, s6, 160
  buffer_load_ushort v14, v140, s[48:51], s70 offen
  buffer_load_ushort v15, v143, s[48:51], s70 offen offset:128
L_a_nox:
  s_mul_i32 s80, s8, 1093
  s_lshr_b32 s80, s80, 16
  s_mul_i32 s81, s80, 60
  s_sub_u32 s81, s8, s81
  s_cmp_lt_u32 s8, 240
  s_cselect_b32 s71, 4915200, 0
  s_cselect_b32 s72, 1280, 0
  s_mov_b32 s44, s36
  s_and_b32 s45, s37, 0xffff
  s_mov_b32 s46, s71
  s_mov_b32 s47, 0x20000
  s_mov_b32 s52, s34
  s_and_b32 s53, s35, 0xffff
  s_mov_b32 s54, s72
  s_mov_b32 s55, 0x20000
  s_mul_i32 s70, s80, 160
  s_mul_i32 s71, s3, 40
  s_add_u32 s70, s70, s71
  v_mul_u32_u24 v139, 7680, v136
  v_add_u32 v139, v139, v137
  s_mul_i32 s71, s70, 7680
  s_lshl_b32 s72, s81, 7
  s_add_u32 s71, s71, s72
  v_lshlrev_b32 v140, 1, v1
  s_lshl_b32 s70, s70, 1
  buffer_load_ushort v9, v140, s[52:55], s70 offen
  buffer_load_dwordx4 v[20:23], v139, s[44:47], s71 offen nt
  s_add_u32 s71, s71, 61440
  buffer_load_dwordx4 v[24:27], v139, s[44:47], s71 offen nt
  s_add_u32 s71, s71, 61440
  buffer_load_dwordx4 v[28:31], v139, s[44:47], s71 offen nt
  s_add_u32 s71, s71, 61440
  buffer_load_dwordx4 v[32:35], v139, s[44:47], s71 offen nt
  s_add_u32 s71, s71, 61440
  buffer_load_dwordx4 v[36:39], v139, s[44:47], s71 offen nt
  s_cmp_lg_u32 s3, 2
  s_cbranch_scc1 L_a_not2
  buffer_load_dword v140, v3, s[56:59], 0 offen sc1
L_a_not2:
  s_mov_b32 s44, s22
  s_and_b32 s45, s23, 0xffff
  s_mov_b32 s46, 7864320
  s_mov_b32 s47, 0x20000
  v_mul_u32_u24 v139, 12288, v136
  v_add_u32 v139, v139, v137
  s_mul_i32 s70, s6, 10
  s_add_u32 s70, s70, s3
  s_mul_i32 s70, s70, 98304
  s_mul_i32 s71, s5, 384
  s_add_u32 s70, s70, s71
  buffer_load_dwordx4 v[100:103], v139, s[44:47], s70 offen offset:0 nt
  buffer_load_dwordx4 v[104:107], v139, s[44:47], s70 offen offset:128 nt
  buffer_load_dwordx4 v[108:111], v139, s[44:47], s70 offen offset:256 nt
  s_add_u32 s70, s70, 393216
  buffer_load_dwordx4 v[112:115], v139, s[44:47], s70 offen offset:0 nt
  buffer_load_dwordx4 v[116:119], v139, s[44:47], s70 offen offset:128 nt
  buffer_load_dwordx4 v[120:123], v139, s[44:47], s70 offen offset:256 nt
  s_add_u32 s70, s70, 393216
  s_cmp_lt_u32 s3, 2
  s_cselect_b32 s70, s70, 0x7f000000
  buffer_load_dwordx4 v[124:127], v139, s[44:47], s70 offen offset:0 nt
  buffer_load_dwordx4 v[128:131], v139, s[44:47], s70 offen offset:128 nt
  buffer_load_dwordx4 v[132:135], v139, s[44:47], s70 offen offset:256 nt
  s_mov_b32 s64, s42
  s_and_b32 s65, s43, 0xffff
  s_mov_b32 s66, 1966080
  s_mov_b32 s67, 0x20000
  s_mov_b32 s48, s42
  s_and_b32 s49, s43, 0xffff
  s_mov_b32 s50, 1966080
  s_mov_b32 s51, 0x20000
  s_mov_b32 s52, s42
  s_and_b32 s53, s43, 0xffff
  s_mov_b32 s54, 1966080
  s_mov_b32 s55, 0x20000
  v_and_b32 v143, 8, v1
  v_cmp_ne_u32 s[68:69], 0, v143
  s_cmp_lg_u32 s3, 2
  s_cbranch_scc1 L_a_nn
  s_mov_b32 s90, 0
  s_waitcnt vmcnt(9)
L_a_np:
  s_nop 0
  v_readfirstlane_b32 s7, v140
  s_cmp_lg_u32 s7, 0
  s_cbranch_scc1 L_a_nd
  buffer_load_dword v140, v3, s[56:59], 0 offen sc1
  s_waitcnt vmcnt(0)
  s_add_u32 s90, s90, 1
  s_cmp_lt_u32 s90, 65536
  s_cbranch_scc1 L_a_np
  s_mov_b32 s7, 1
  v_mov_b32 v140, 1
L_a_nd:
  ds_write_b32 v3, v140 offset:16
L_a_nn:
  s_cmp_ge_u32 s8, 240
  s_cbranch_scc1 L_a_noM
  s_waitcnt vmcnt(14)
  v_lshlrev_b32 v9, 16, v9
  v_mul_f32 v10, 0xbfb8aa3b, v9
  v_exp_f32 v10, v10
  s_nop 0
  v_add_f32 v10, 1.0, v10
  v_rcp_f32 v10, v10
  s_nop 0
  v_mul_f32 v9, v9, v10
  v_cvt_pk_bf16_f32 v9, v9, 0
  v_lshlrev_b32 v11, 2, v136
  v_add_u32 v12, 0, v11
  ds_bpermute_b32 v144, v12, v9
  v_add_u32 v12, 32, v11
  ds_bpermute_b32 v145, v12, v9
  v_add_u32 v12, 64, v11
  ds_bpermute_b32 v146, v12, v9
  v_add_u32 v12, 96, v11
  ds_bpermute_b32 v147, v12, v9
  v_add_u32 v12, 128, v11
  ds_bpermute_b32 v148, v12, v9
  s_waitcnt lgkmcnt(0)
  v_lshlrev_b32 v149, 16, v144
  v_lshlrev_b32 v150, 16, v145
  v_lshlrev_b32 v151, 16, v146
  v_lshlrev_b32 v152, 16, v147
  v_lshlrev_b32 v153, 16, v148
  s_waitcnt vmcnt(9)
  v_dot2_f32_bf16 v156, v20, v144, 0
  v_dot2_f32_bf16 v157, v20, v149, 0
  v_dot2_f32_bf16 v158, v21, v144, 0
  v_dot2_f32_bf16 v159, v21, v149, 0
  v_dot2_f32_bf16 v160, v22, v144, 0
  v_dot2_f32_bf16 v161, v22, v149, 0
  v_dot2_f32_bf16 v162, v23, v144, 0
  v_dot2_f32_bf16 v163, v23, v149, 0
  v_dot2_f32_bf16 v156, v24, v145, v156
  v_dot2_f32_bf16 v157, v24, v150, v157
  v_dot2_f32_bf16 v158, v25, v145, v158
  v_dot2_f32_bf16 v159, v25, v150, v159
  v_dot2_f32_bf16 v160, v26, v145, v160
  v_dot2_f32_bf16 v161, v26, v150, v161
  v_dot2_f32_bf16 v162, v27, v145, v162
  v_dot2_f32_bf16 v163, v27, v150, v163
  v_dot2_f32_bf16 v156, v28, v146, v156
  v_dot2_f32_bf16 v157, v28, v151, v157
  v_dot2_f32_bf16 v158, v29, v146, v158
  v_dot2_f32_bf16 v159, v29, v151, v159
  v_dot2_f32_bf16 v160, v30, v146, v160
  v_dot2_f32_bf16 v161, v30, v151, v161
  v_dot2_f32_bf16 v162, v31, v146, v162
  v_dot2_f32_bf16 v163, v31, v151, v163
  v_dot2_f32_bf16 v156, v32, v147, v156
  v_dot2_f32_bf16 v157, v32, v152, v157
  v_dot2_f32_bf16 v158, v33, v147, v158
  v_dot2_f32_bf16 v159, v33, v152, v159
  v_dot2_f32_bf16 v160, v34, v147, v160
  v_dot2_f32_bf16 v161, v34, v152, v161
  v_dot2_f32_bf16 v162, v35, v147, v162
  v_dot2_f32_bf16 v163, v35, v152, v163
  v_dot2_f32_bf16 v156, v36, v148, v156
  v_dot2_f32_bf16 v157, v36, v153, v157
  v_dot2_f32_bf16 v158, v37, v148, v158
  v_dot2_f32_bf16 v159, v37, v153, v159
  v_dot2_f32_bf16 v160, v38, v148, v160
  v_dot2_f32_bf16 v161, v38, v153, v161
  v_dot2_f32_bf16 v162, v39, v148, v162
  v_dot2_f32_bf16 v163, v39, v153, v163
  v_permlane32_swap_b32 v156, v160
  v_permlane32_swap_b32 v157, v161
  v_permlane32_swap_b32 v158, v162
  v_permlane32_swap_b32 v159, v163
  v_add_f32 v156, v156, v160
  v_add_f32 v157, v157, v161
  v_add_f32 v158, v158, v162
  v_add_f32 v159, v159, v163
  s_nop 0
  v_permlane16_swap_b32 v156, v158
  v_permlane16_swap_b32 v157, v159
  v_add_f32 v156, v156, v158
  v_add_f32 v157, v157, v159
  s_nop 0
  v_add_f32_dpp v156, v156, v156 row_ror:8 row_mask:0xf bank_mask:0xf
  v_add_f32_dpp v157, v157, v157 row_ror:8 row_mask:0xf bank_mask:0xf
  v_cndmask_b32 v156, v156, v157, s[68:69]
  v_and_b32 v144, 7, v1
  v_lshlrev_b32 v144, 5, v144
  v_lshrrev_b32 v145, 5, v1
  v_lshl_add_u32 v144, v145, 4, v144
  v_bfe_u32 v145, v1, 4, 1
  v_lshl_add_u32 v144, v145, 3, v144
  v_bfe_u32 v145, v1, 3, 1
  v_lshl_add_u32 v144, v145, 2, v144
  s_lshl_b32 s70, s3, 8
  v_add_u32 v144, s70, v144
  ds_write_b32 v144, v156 offset:2048
  s_mov_b64 s[88:89], exec
  s_mov_b64 exec, 1
  ds_add_u32 v3, v2 offset:20
  s_mov_b64 exec, s[88:89]
  s_cmp_lg_u32 s3, 0
  s_cbranch_scc1 L_a_noM
  s_mov_b32 s90, 0
LWm_33:
  ds_read_b32 v144, v3 offset:20
  s_waitcnt lgkmcnt(0)
  v_readfirstlane_b32 s70, v144
  s_cmp_ge_u32 s70, 4
  s_cbranch_scc1 LDm_34
  s_add_u32 s90, s90, 1
  s_cmp_lt_u32 s90, 524288
  s_cbranch_scc1 LWm_33
LDm_34:
  ds_read_b32 v144, v138 offset:2048
  ds_read_b32 v145, v138 offset:2304
  ds_read_b32 v146, v138 offset:2560
  ds_read_b32 v147, v138 offset:2816
  s_mov_b32 s90, 0
LWn0_35:
  ds_read_b32 v148, v3 offset:16
  s_waitcnt lgkmcnt(0)
  v_readfirstlane_b32 s7, v148
  s_cmp_ge_u32 s7, 1
  s_cbranch_scc1 LDn0_36
  s_add_u32 s90, s90, 1
  s_cmp_lt_u32 s90, 524288
  s_cbranch_scc1 LWn0_35
LDn0_36:
  v_add_f32 v144, v144, v145
  v_add_f32 v146, v146, v147
  v_add_f32 v144, v144, v146
  v_mov_b32 v145, s7
  s_mul_i32 s70, s80, 30720
  s_lshl_b32 s71, s81, 9
  s_add_u32 s70, s70, s71
  s_add_u32 s70, s70, 1048576
  v_lshlrev_b32 v146, 3, v1
  buffer_store_dwordx2 v[144:145], v146, s[64:67], s70 offen sc1
L_a_noM:
  s_cmp_eq_u32 s3, 0
  s_cbranch_scc1 L_a_w0
  s_cmp_eq_u32 s3, 2
  s_cbranch_scc1 L_a_w2
  s_cmp_eq_u32 s3, 3
  s_cbranch_scc1 L_a_w3
  s_branch L_a_wdone
L_a_w0:
  s_mov_b64 exec, 0
  s_branch L_ch_q
L_ch_q_ret:
  s_mov_b64 exec, -1
  s_branch L_a_wdone
L_a_w2:
  s_mov_b64 exec, 0
  s_branch L_ch_bulk
L_ch_bulk_ret:
  s_mov_b64 exec, -1
  s_branch L_a_wdone
L_a_w3:
  s_cmp_lt_u32 s8, 160
  s_cbranch_scc0 L_a_w3a
  s_mov_b64 exec, 0
  s_branch L_ch_wo
L_ch_wo_ret:
  s_mov_b64 exec, -1
  s_branch L_a_wdone
L_a_w3a:
  s_cmp_lt_u32 s8, 208
  s_cbranch_scc0 L_a_w3b
  s_mov_b64 exec, 0
  s_branch L_ch_gu
L_ch_gu_ret:
  s_mov_b64 exec, -1
  s_mov_b64 exec, 0
  s_branch L_ch_gx
L_ch_gx_ret:
  s_mov_b64 exec, -1
  s_branch L_a_wdone
L_a_w3b:
  s_cmp_lt_u32 s8, 228
  s_cbranch_scc0 L_a_wdone
  s_mov_b64 exec, 0
  s_branch L_ch_dn
L_ch_dn_ret:
  s_mov_b64 exec, -1
L_a_wdone:
L_ch_q:
L_pad_84:
  s_cbranch_execz L_pad_85
  s_mov_b32 s90, 0
LWn_37:
  ds_read_b32 v140, v3 offset:16
  s_waitcnt lgkmcnt(0)
  v_readfirstlane_b32 s7, v140
  s_cmp_ge_u32 s7, 1
  s_cbranch_scc1 LDn_38
  s_sleep 1
  s_add_u32 s90, s90, 1
  s_cmp_lt_u32 s90, 524288
  s_cbranch_scc1 LWn_37
LDn_38:
  s_cmp_lg_u32 s3, 1
  s_cbranch_scc1 L_a_noh
  s_waitcnt vmcnt(0)
  v_lshlrev_b32 v40, 16, v4
  v_and_b32 v41, 0xffff0000, v4
  v_lshlrev_b32 v42, 16, v5
  v_and_b32 v43, 0xffff0000, v5
  v_lshlrev_b32 v44, 16, v6
  v_and_b32 v45, 0xffff0000, v6
  v_lshlrev_b32 v46, 16, v7
  v_and_b32 v47, 0xffff0000, v7
  v_lshlrev_b32 v48, 16, v8
  v_and_b32 v49, 0xffff0000, v8
  v_add_f32 v50, v40, v41
  v_add_f32 v50, v50, v42
  v_add_f32 v50, v50, v43
L_pad_85:
  s_cbranch_execz L_pad_86
  v_add_f32 v50, v50, v44
  v_add_f32 v50, v50, v45
  v_add_f32 v50, v50, v46
  v_add_f32 v50, v50, v47
  v_add_f32 v50, v50, v48
  v_add_f32 v50, v50, v49
  s_nop 1
  v_add_f32_dpp v50, v50, v50 quad_perm:[1,0,3,2] row_mask:0xf bank_mask:0xf
  s_nop 1
  v_add_f32_dpp v50, v50, v50 quad_perm:[2,3,0,1] row_mask:0xf bank_mask:0xf
  s_nop 1
  v_add_f32_dpp v50, v50, v50 row_half_mirror row_mask:0xf bank_mask:0xf
  s_nop 1
  v_add_f32_dpp v50, v50, v50 row_ror:8 row_mask:0xf bank_mask:0xf
  v_mov_b32 v52, v50
  s_nop 1
  v_permlane16_swap_b32 v52, v50
  v_add_f32 v50, v52, v50
  v_mov_b32 v52, v50
  s_nop 1
  v_permlane32_swap_b32 v52, v50
  v_add_f32 v50, v52, v50
  v_mul_f32 v50, 0x3acccccd, v50
  v_sub_f32 v52, v40, v50
  v_mul_f32 v51, v52, v52
  v_sub_f32 v52, v41, v50
L_pad_86:
  s_cbranch_execz L_pad_87
  v_fmac_f32 v51, v52, v52
  v_sub_f32 v52, v42, v50
  v_fmac_f32 v51, v52, v52
  v_sub_f32 v52, v43, v50
  v_fmac_f32 v51, v52, v52
  v_sub_f32 v52, v44, v50
  v_fmac_f32 v51, v52, v52
  v_sub_f32 v52, v45, v50
  v_fmac_f32 v51, v52, v52
  v_sub_f32 v52, v46, v50
  v_fmac_f32 v51, v52, v52
  v_sub_f32 v52, v47, v50
  v_fmac_f32 v51, v52, v52
  v_sub_f32 v52, v48, v50
  v_fmac_f32 v51, v52, v52
  v_sub_f32 v52, v49, v50
  v_fmac_f32 v51, v52, v52
  s_nop 1
  v_add_f32_dpp v51, v51, v51 quad_perm:[1,0,3,2] row_mask:0xf bank_mask:0xf
  s_nop 1
  v_add_f32_dpp v51, v51, v51 quad_perm:[2,3,0,1] row_mask:0xf bank_mask:0xf
  s_nop 1
  v_add_f32_dpp v51, v51, v51 row_half_mirror row_mask:0xf bank_mask:0xf
  s_nop 1
  v_add_f32_dpp v51, v51, v51 row_ror:8 row_mask:0xf bank_mask:0xf
L_pad_87:
  s_cbranch_execz L_pad_88
  v_mov_b32 v52, v51
  s_nop 1
  v_permlane16_swap_b32 v52, v51
  v_add_f32 v51, v52, v51
  v_mov_b32 v52, v51
  s_nop 1
  v_permlane32_swap_b32 v52, v51
  v_add_f32 v51, v52, v51
  v_mul_f32 v51, 0x3acccccd, v51
  v_cvt_pk_bf16_f32 v51, v51, v51
  v_lshlrev_b32 v51, 16, v51
  v_add_f32 v51, 0x3727c5ac, v51
  v_cvt_pk_bf16_f32 v51, v51, v51
  v_lshlrev_b32 v51, 16, v51
  v_sqrt_f32 v51, v51
  s_nop 0
  v_cvt_pk_bf16_f32 v51, v51, v51
  v_lshlrev_b32 v51, 16, v51
  v_cvt_pk_bf16_f32 v50, v50, v50
  v_lshlrev_b32 v50, 16, v50
  v_rcp_f32 v51, v51
  v_lshrrev_b32 v52, 4, v1
  v_mul_u32_u24 v52, 30720, v52
  v_and_b32 v53, 15, v1
  v_lshl_add_u32 v52, v53, 4, v52
L_pad_88:
  s_cbranch_execz L_pad_89
  s_mul_i32 s70, s6, 640
  s_add_u32 s70, s70, 1048576
  s_add_u32 s71, s70, 5120
  s_mov_b32 s90, 0
PLh_39:
  buffer_load_dwordx4 v[56:59], v52, s[64:67], s70 offen offset:0 sc1
  buffer_load_dwordx4 v[60:63], v52, s[64:67], s70 offen offset:256 sc1
  buffer_load_dwordx4 v[64:67], v52, s[64:67], s70 offen offset:512 sc1
  buffer_load_dwordx4 v[68:71], v52, s[64:67], s71 offen offset:0 sc1
  buffer_load_dwordx4 v[72:75], v52, s[64:67], s71 offen offset:256 sc1
  buffer_load_dwordx4 v[76:79], v52, s[64:67], s71 offen offset:512 sc1
  s_waitcnt vmcnt(0)
  v_cmp_ne_u32 s[92:93], s7, v57
  v_cmp_ne_u32 vcc, s7, v59
  s_or_b64 s[92:93], s[92:93], vcc
  v_cmp_ne_u32 vcc, s7, v61
  s_or_b64 s[92:93], s[92:93], vcc
  v_cmp_ne_u32 vcc, s7, v63
  s_or_b64 s[92:93], s[92:93], vcc
  v_cmp_ne_u32 vcc, s7, v65
  s_or_b64 s[92:93], s[92:93], vcc
  v_cmp_ne_u32 vcc, s7, v67
  s_or_b64 s[92:93], s[92:93], vcc
  v_cmp_ne_u32 vcc, s7, v69
  s_or_b64 s[92:93], s[92:93], vcc
L_pad_89:
  s_cbranch_execz L_pad_90
  v_cmp_ne_u32 vcc, s7, v71
  s_or_b64 s[92:93], s[92:93], vcc
  v_cmp_ne_u32 vcc, s7, v73
  s_or_b64 s[92:93], s[92:93], vcc
  v_cmp_ne_u32 vcc, s7, v75
  s_or_b64 s[92:93], s[92:93], vcc
  v_cmp_ne_u32 vcc, s7, v77
  s_or_b64 s[92:93], s[92:93], vcc
  v_cmp_ne_u32 vcc, s7, v79
  s_or_b64 s[92:93], s[92:93], vcc
  s_cmp_eq_u64 s[92:93], 0
  s_cbranch_scc1 PDh_40
  s_sleep 2
  s_add_u32 s90, s90, 1
  s_cmp_lt_u32 s90, 65536
  s_cbranch_scc1 PLh_39
PDh_40:
  s_nop 1
  v_permlane32_swap_b32 v56, v58
  v_permlane32_swap_b32 v60, v62
  v_permlane32_swap_b32 v64, v66
  v_add_f32 v56, v56, v58
  v_add_f32 v60, v60, v62
  v_add_f32 v64, v64, v66
  s_nop 0
  v_permlane16_swap_b32 v56, v60
  v_add_f32 v56, v56, v60
L_pad_90:
  s_cbranch_execz L_pad_91
  v_mov_b32 v53, v64
  s_nop 1
  v_permlane16_swap_b32 v53, v64
  v_add_f32 v64, v53, v64
  v_permlane32_swap_b32 v68, v70
  v_permlane32_swap_b32 v72, v74
  v_permlane32_swap_b32 v76, v78
  v_add_f32 v68, v68, v70
  v_add_f32 v72, v72, v74
  v_add_f32 v76, v76, v78
  s_nop 0
  v_permlane16_swap_b32 v68, v72
  v_add_f32 v68, v68, v72
  v_mov_b32 v53, v76
  s_nop 1
  v_permlane16_swap_b32 v53, v76
  v_add_f32 v76, v53, v76
  v_lshlrev_b32 v40, 16, v14
  v_lshlrev_b32 v41, 16, v15
  v_cvt_pk_bf16_f32 v56, v56, v56
  v_lshlrev_b32 v56, 16, v56
  v_cvt_pk_bf16_f32 v64, v64, v64
  v_lshlrev_b32 v64, 16, v64
  v_cvt_pk_bf16_f32 v68, v68, v68
  v_lshlrev_b32 v68, 16, v68
L_pad_91:
  s_cbranch_execz L_pad_92
  v_cvt_pk_bf16_f32 v76, v76, v76
  v_lshlrev_b32 v76, 16, v76
  v_add_f32 v68, 1.0, v68
  v_add_f32 v76, 1.0, v76
  v_cvt_pk_bf16_f32 v68, v68, v68
  v_lshlrev_b32 v68, 16, v68
  v_cvt_pk_bf16_f32 v76, v76, v76
  v_lshlrev_b32 v76, 16, v76
  v_sub_f32 v40, v40, v50
  v_sub_f32 v41, v41, v50
  v_cvt_pk_bf16_f32 v40, v40, v40
  v_lshlrev_b32 v40, 16, v40
  v_cvt_pk_bf16_f32 v41, v41, v41
  v_lshlrev_b32 v41, 16, v41
  v_mul_f32 v40, v40, v51
  v_mul_f32 v41, v41, v51
  v_cvt_pk_bf16_f32 v40, v40, v40
  v_lshlrev_b32 v40, 16, v40
  v_cvt_pk_bf16_f32 v41, v41, v41
  v_lshlrev_b32 v41, 16, v41
  v_mul_f32 v40, v40, v68
  v_mul_f32 v41, v41, v76
  v_cvt_pk_bf16_f32 v40, v40, v40
L_pad_92:
  s_cbranch_execz L_pad_93
  v_lshlrev_b32 v40, 16, v40
  v_cvt_pk_bf16_f32 v41, v41, v41
  v_lshlrev_b32 v41, 16, v41
  v_add_f32 v40, v40, v56
  v_add_f32 v41, v41, v64
  v_cvt_pk_bf16_f32 v40, v40, v40
  v_lshlrev_b32 v40, 16, v40
  v_cvt_pk_bf16_f32 v41, v41, v41
  v_lshlrev_b32 v41, 16, v41
  v_lshrrev_b32 v44, 16, v40
  v_mov_b32 v45, v40
  v_lshrrev_b32 v46, 16, v41
  v_mov_b32 v47, v41
  v_cmp_gt_u32 vcc, 16, v141
  s_nop 1
  v_cndmask_b32 v46, 0, v46, vcc
  v_cndmask_b32 v47, 0, v47, vcc
  v_lshlrev_b32 v52, 3, v142
  v_lshlrev_b32 v53, 3, v141
  ds_write_b64 v52, v[44:45] offset:1024
  ds_write_b64 v53, v[46:47] offset:1536
  s_waitcnt lgkmcnt(0)
  ds_write_b32 v3, v2 offset:24
L_a_noh:
  s_mov_b32 s90, 0
LWh_41:
L_pad_93:
  s_cbranch_execz L_pad_94
  ds_read_b32 v140, v3 offset:24
  s_waitcnt lgkmcnt(0)
  v_readfirstlane_b32 s70, v140
  s_cmp_ge_u32 s70, 1
  s_cbranch_scc1 LDh_42
  s_sleep 1
  s_add_u32 s90, s90, 1
  s_cmp_lt_u32 s90, 524288
  s_cbranch_scc1 LWh_41
LDh_42:
  s_lshl_b32 s70, s3, 6
  v_lshlrev_b32 v140, 3, v136
  v_add_u32 v140, s70, v140
  ds_read_b64 v[144:145], v140 offset:1024
  ds_read_b64 v[146:147], v140 offset:1280
  ds_read_b64 v[148:149], v140 offset:1536
  s_waitcnt vmcnt(0) lgkmcnt(0)
  v_dot2_f32_bf16 v20, v100, v144, 0
  v_dot2_f32_bf16 v21, v100, v145, 0
  v_dot2_f32_bf16 v22, v101, v144, 0
  v_dot2_f32_bf16 v23, v101, v145, 0
  v_dot2_f32_bf16 v24, v102, v144, 0
  v_dot2_f32_bf16 v25, v102, v145, 0
  v_dot2_f32_bf16 v26, v103, v144, 0
  v_dot2_f32_bf16 v27, v103, v145, 0
  v_dot2_f32_bf16 v28, v104, v144, 0
  v_dot2_f32_bf16 v29, v104, v145, 0
L_pad_94:
  s_cbranch_execz L_pad_95
  v_dot2_f32_bf16 v30, v105, v144, 0
  v_dot2_f32_bf16 v31, v105, v145, 0
  v_dot2_f32_bf16 v32, v106, v144, 0
  v_dot2_f32_bf16 v33, v106, v145, 0
  v_dot2_f32_bf16 v34, v107, v144, 0
  v_dot2_f32_bf16 v35, v107, v145, 0
  v_dot2_f32_bf16 v36, v108, v144, 0
  v_dot2_f32_bf16 v37, v108, v145, 0
  v_dot2_f32_bf16 v38, v109, v144, 0
  v_dot2_f32_bf16 v39, v109, v145, 0
  v_dot2_f32_bf16 v40, v110, v144, 0
  v_dot2_f32_bf16 v41, v110, v145, 0
  v_dot2_f32_bf16 v42, v111, v144, 0
  v_dot2_f32_bf16 v43, v111, v145, 0
  v_dot2_f32_bf16 v20, v112, v146, v20
  v_dot2_f32_bf16 v21, v112, v147, v21
  v_dot2_f32_bf16 v22, v113, v146, v22
  v_dot2_f32_bf16 v23, v113, v147, v23
  v_dot2_f32_bf16 v24, v114, v146, v24
  v_dot2_f32_bf16 v25, v114, v147, v25
  v_dot2_f32_bf16 v26, v115, v146, v26
  v_dot2_f32_bf16 v27, v115, v147, v27
  v_dot2_f32_bf16 v28, v116, v146, v28
L_pad_95:
  s_cbranch_execz L_pad_96
  v_dot2_f32_bf16 v29, v116, v147, v29
  v_dot2_f32_bf16 v30, v117, v146, v30
  v_dot2_f32_bf16 v31, v117, v147, v31
  v_dot2_f32_bf16 v32, v118, v146, v32
  v_dot2_f32_bf16 v33, v118, v147, v33
  v_dot2_f32_bf16 v34, v119, v146, v34
  v_dot2_f32_bf16 v35, v119, v147, v35
  v_dot2_f32_bf16 v36, v120, v146, v36
  v_dot2_f32_bf16 v37, v120, v147, v37
  v_dot2_f32_bf16 v38, v121, v146, v38
  v_dot2_f32_bf16 v39, v121, v147, v39
  v_dot2_f32_bf16 v40, v122, v146, v40
  v_dot2_f32_bf16 v41, v122, v147, v41
  v_dot2_f32_bf16 v42, v123, v146, v42
  v_dot2_f32_bf16 v43, v123, v147, v43
  v_dot2_f32_bf16 v20, v124, v148, v20
  v_dot2_f32_bf16 v21, v124, v149, v21
  v_dot2_f32_bf16 v22, v125, v148, v22
  v_dot2_f32_bf16 v23, v125, v149, v23
  v_dot2_f32_bf16 v24, v126, v148, v24
  v_dot2_f32_bf16 v25, v126, v149, v25
  v_dot2_f32_bf16 v26, v127, v148, v26
  v_dot2_f32_bf16 v27, v127, v149, v27
L_pad_96:
  s_cbranch_execz L_pad_97
  v_dot2_f32_bf16 v28, v128, v148, v28
  v_dot2_f32_bf16 v29, v128, v149, v29
  v_dot2_f32_bf16 v30, v129, v148, v30
  v_dot2_f32_bf16 v31, v129, v149, v31
  v_dot2_f32_bf16 v32, v130, v148, v32
  v_dot2_f32_bf16 v33, v130, v149, v33
  v_dot2_f32_bf16 v34, v131, v148, v34
  v_dot2_f32_bf16 v35, v131, v149, v35
  v_dot2_f32_bf16 v36, v132, v148, v36
  v_dot2_f32_bf16 v37, v132, v149, v37
  v_dot2_f32_bf16 v38, v133, v148, v38
  v_dot2_f32_bf16 v39, v133, v149, v39
  v_dot2_f32_bf16 v40, v134, v148, v40
  v_dot2_f32_bf16 v41, v134, v149, v41
  v_dot2_f32_bf16 v42, v135, v148, v42
  v_dot2_f32_bf16 v43, v135, v149, v43
  v_permlane32_swap_b32 v20, v24
  v_permlane32_swap_b32 v21, v25
  v_permlane32_swap_b32 v22, v26
  v_permlane32_swap_b32 v23, v27
  v_permlane32_swap_b32 v28, v32
  v_permlane32_swap_b32 v29, v33
  v_permlane32_swap_b32 v30, v34
L_pad_97:
  s_cbranch_execz L_pad_98
  v_permlane32_swap_b32 v31, v35
  v_permlane32_swap_b32 v36, v40
  v_permlane32_swap_b32 v37, v41
  v_permlane32_swap_b32 v38, v42
  v_permlane32_swap_b32 v39, v43
  v_add_f32 v20, v20, v24
  v_add_f32 v21, v21, v25
  v_add_f32 v22, v22, v26
  v_add_f32 v23, v23, v27
  v_add_f32 v28, v28, v32
  v_add_f32 v29, v29, v33
  v_add_f32 v30, v30, v34
  v_add_f32 v31, v31, v35
  v_add_f32 v36, v36, v40
  v_add_f32 v37, v37, v41
  v_add_f32 v38, v38, v42
  v_add_f32 v39, v39, v43
  v_permlane16_swap_b32 v20, v22
  v_permlane16_swap_b32 v21, v23
  v_permlane16_swap_b32 v28, v30
  v_permlane16_swap_b32 v29, v31
  v_permlane16_swap_b32 v36, v38
  v_permlane16_swap_b32 v37, v39
L_pad_98:
  s_cbranch_execz L_pad_99
  v_add_f32 v20, v20, v22
  v_add_f32 v21, v21, v23
  v_add_f32 v28, v28, v30
  v_add_f32 v29, v29, v31
  v_add_f32 v36, v36, v38
  v_add_f32 v37, v37, v39
  v_add_f32_dpp v20, v20, v20 row_ror:8 row_mask:0xf bank_mask:0xf
  v_add_f32_dpp v21, v21, v21 row_ror:8 row_mask:0xf bank_mask:0xf
  v_add_f32_dpp v28, v28, v28 row_ror:8 row_mask:0xf bank_mask:0xf
  v_add_f32_dpp v29, v29, v29 row_ror:8 row_mask:0xf bank_mask:0xf
  v_add_f32_dpp v36, v36, v36 row_ror:8 row_mask:0xf bank_mask:0xf
  v_add_f32_dpp v37, v37, v37 row_ror:8 row_mask:0xf bank_mask:0xf
  v_and_b32 v140, 7, v1
  v_lshlrev_b32 v140, 5, v140
  v_lshrrev_b32 v141, 5, v1
  v_lshl_add_u32 v140, v141, 4, v140
  v_bfe_u32 v141, v1, 4, 1
  v_lshl_add_u32 v140, v141, 3, v140
  s_mul_i32 s70, s3, 768
  v_add_u32 v140, s70, v140
  ds_write_b64 v140, v[20:21] offset:4096
  ds_write_b64 v140, v[28:29] offset:4352
  ds_write_b64 v140, v[36:37] offset:4608
L_pad_99:
  s_cbranch_execz L_pad_100
  s_mov_b64 s[88:89], exec
  s_mov_b64 exec, 1
  ds_add_u32 v3, v2 offset:28
  s_mov_b64 exec, s[88:89]
  s_cmp_eq_u32 s3, 3
  s_cbranch_scc1 L_a_mid
  s_lshl_b32 s70, s3, 6
  v_add_u32 v140, s70, v1
  v_lshlrev_b32 v141, 2, v140
  v_lshlrev_b32 v142, 3, v140
  v_lshlrev_b32 v143, 1, v140
  s_mul_i32 s70, s4, 1536
  s_add_u32 s70, s70, 262144
  s_mul_i32 s71, s5, 12288
  s_add_u32 s71, s71, 262144
  s_add_u32 s72, s71, 1536
  s_add_u32 s73, s71, 3072
  s_add_u32 s74, s71, 4608
  s_add_u32 s75, s71, 6144
  s_add_u32 s76, s71, 7680
  s_add_u32 s77, s71, 9216
  s_add_u32 s78, s71, 10752
  s_mov_b32 s90, 0
LWqp_43:
  ds_read_b32 v144, v3 offset:28
L_pad_100:
  s_cbranch_execz L_pad_101
  s_waitcnt lgkmcnt(0)
  v_readfirstlane_b32 s79, v144
  s_cmp_ge_u32 s79, 4
  s_cbranch_scc1 LDqp_44
  s_add_u32 s90, s90, 1
  s_cmp_lt_u32 s90, 524288
  s_cbranch_scc1 LWqp_43
LDqp_44:
  ds_read_b32 v144, v141 offset:4096
  ds_read_b32 v145, v141 offset:4864
  ds_read_b32 v146, v141 offset:5632
  ds_read_b32 v147, v141 offset:6400
  s_waitcnt lgkmcnt(0)
  v_add_f32 v144, v144, v145
  v_add_f32 v146, v146, v147
  v_add_f32 v144, v144, v146
  v_mov_b32 v145, s7
  buffer_store_dwordx2 v[144:145], v142, s[64:67], s70 offen sc1
  s_mov_b32 s90, 0
PLq_45:
  buffer_load_dwordx2 v[20:21], v142, s[64:67], s71 offen sc1
  buffer_load_dwordx2 v[22:23], v142, s[64:67], s72 offen sc1
  buffer_load_dwordx2 v[24:25], v142, s[64:67], s73 offen sc1
  buffer_load_dwordx2 v[26:27], v142, s[64:67], s74 offen sc1
  buffer_load_dwordx2 v[28:29], v142, s[64:67], s75 offen sc1
  buffer_load_dwordx2 v[30:31], v142, s[64:67], s76 offen sc1
  buffer_load_dwordx2 v[32:33], v142, s[64:67], s77 offen sc1
L_pad_101:
  s_cbranch_execz L_pad_102
  buffer_load_dwordx2 v[34:35], v142, s[64:67], s78 offen sc1
  s_waitcnt vmcnt(0)
  v_cmp_ne_u32 s[92:93], s7, v21
  v_cmp_ne_u32 vcc, s7, v23
  s_or_b64 s[92:93], s[92:93], vcc
  v_cmp_ne_u32 vcc, s7, v25
  s_or_b64 s[92:93], s[92:93], vcc
  v_cmp_ne_u32 vcc, s7, v27
  s_or_b64 s[92:93], s[92:93], vcc
  v_cmp_ne_u32 vcc, s7, v29
  s_or_b64 s[92:93], s[92:93], vcc
  v_cmp_ne_u32 vcc, s7, v31
  s_or_b64 s[92:93], s[92:93], vcc
  v_cmp_ne_u32 vcc, s7, v33
  s_or_b64 s[92:93], s[92:93], vcc
  v_cmp_ne_u32 vcc, s7, v35
  s_or_b64 s[92:93], s[92:93], vcc
  s_cmp_eq_u64 s[92:93], 0
  s_cbranch_scc1 PDq_46
  s_sleep 1
  s_add_u32 s90, s90, 1
  s_cmp_lt_u32 s90, 65536
  s_cbranch_scc1 PLq_45
PDq_46:
  v_add_f32 v20, v20, v22
  v_add_f32 v20, v20, v24
L_pad_102:
  s_cbranch_execz L_pad_103
  v_add_f32 v20, v20, v26
  v_add_f32 v20, v20, v28
  v_add_f32 v20, v20, v30
  v_add_f32 v20, v20, v32
  v_add_f32 v20, v20, v34
  v_cvt_pk_bf16_f32 v20, v20, v20
  ds_write_b16 v143, v20 offset:512
  s_mov_b64 s[88:89], exec
  s_mov_b64 exec, 1
  ds_add_u32 v3, v2 offset:0
  s_mov_b64 exec, s[88:89]
L_a_mid:
  s_cmp_lt_u32 s8, 80
  s_cbranch_scc1 L_own
  s_cmp_lt_u32 s8, 160
  s_cbranch_scc1 L_a_mid2
  s_cmp_lt_u32 s8, 208
  s_cbranch_scc1 L_agu
  s_cmp_lt_u32 s8, 228
  s_cbranch_scc1 L_adn
L_a_mid2:
L_a_mid3:
L_pad_103:
  s_cbranch_execz L_ch_q_ret
  s_cmp_lg_u32 s3, 0
  s_cbranch_scc1 L_a_end
  s_cmp_lt_u32 s8, 80
  s_cbranch_scc1 L_own2
  s_cmp_lt_u32 s8, 160
  s_cbranch_scc1 L_a_end
  s_cmp_lt_u32 s8, 208
  s_cbranch_scc1 L_agu2
  s_cmp_lt_u32 s8, 228
  s_cbranch_scc1 L_own2
L_a_end:
  s_endpgm
L_own:
  s_cmp_lg_u32 s3, 0
  s_cbranch_scc1 L_a_mid2
  s_mov_b32 s44, s16
  s_and_b32 s45, s17, 0xffff
  s_mov_b32 s46, 1280
  s_mov_b32 s47, 0x20000
  v_and_b32 v140, 7, v1
  v_lshlrev_b32 v141, 1, v140
  s_lshl_b32 s70, s8, 4
  buffer_load_ushort v144, v141, s[44:47], s70 offen
  v_bfe_u32 v142, v1, 3, 2
  v_mul_u32_u24 v142, 30720, v142
  v_lshl_add_u32 v142, v140, 3, v142
  s_lshl_b32 s70, s8, 6
  s_add_u32 s70, s70, 1058816
  s_mov_b32 s90, 0
PLga_47:
  buffer_load_dwordx2 v[146:147], v142, s[64:67], s70 offen sc1
  s_waitcnt vmcnt(0)
  v_cmp_ne_u32 s[92:93], s7, v147
  s_cmp_eq_u64 s[92:93], 0
  s_cbranch_scc1 PDga_48
  s_sleep 2
  s_add_u32 s90, s90, 1
  s_cmp_lt_u32 s90, 65536
  s_cbranch_scc1 PLga_47
PDga_48:
  v_lshlrev_b32 v144, 16, v144
  s_nop 0
  v_add_f32_dpp v146, v146, v146 row_ror:8 row_mask:0xf bank_mask:0xf
  v_mov_b32 v148, v146
  s_nop 1
  v_permlane16_swap_b32 v148, v146
  v_add_f32 v146, v148, v146
  v_cvt_pk_bf16_f32 v146, v146, v146
  v_lshlrev_b32 v146, 16, v146
  v_lshlrev_b32 v140, 2, v140
  ds_write_b32 v140, v146 offset:192
  ds_write_b32 v140, v144 offset:224
  s_waitcnt lgkmcnt(0)
  s_branch L_a_mid2
L_own2:
  s_barrier
  s_branch L_a_end
L_adn:
  s_cmp_lg_u32 s3, 0
  s_cbranch_scc1 L_a_mid2
  s_sub_u32 s72, s8, 208
  v_and_b32 v140, 31, v1
  v_lshrrev_b32 v141, 5, v1
  v_mul_u32_u24 v141, 30720, v141
  v_lshl_add_u32 v141, v140, 3, v141
  s_lshl_b32 s70, s72, 8
  s_add_u32 s70, s70, 1074176
  s_add_u32 s71, s70, 61440
  s_mov_b32 s90, 0
PLgb_49:
  buffer_load_dwordx2 v[146:147], v141, s[64:67], s70 offen sc1
  buffer_load_dwordx2 v[148:149], v141, s[64:67], s71 offen sc1
  s_waitcnt vmcnt(0)
  v_cmp_ne_u32 s[92:93], s7, v147
  v_cmp_ne_u32 vcc, s7, v149
  s_or_b64 s[92:93], s[92:93], vcc
  s_cmp_eq_u64 s[92:93], 0
  s_cbranch_scc1 PDgb_50
  s_sleep 2
  s_add_u32 s90, s90, 1
  s_cmp_lt_u32 s90, 65536
  s_cbranch_scc1 PLgb_49
PDgb_50:
  v_add_f32 v146, v146, v148
  v_mov_b32 v148, v146
  s_nop 1
  v_permlane32_swap_b32 v148, v146
  v_add_f32 v146, v148, v146
  v_cvt_pk_bf16_f32 v146, v146, v146
  v_lshlrev_b32 v146, 16, v146
  v_lshlrev_b32 v140, 2, v140
  ds_write_b32 v140, v146 offset:192
  s_waitcnt lgkmcnt(0)
  s_branch L_a_mid2
L_agu:
  s_mov_b32 s90, 0
LWcsq_51:
  ds_read_b32 v145, v3 offset:0
  s_waitcnt lgkmcnt(0)
  v_readfirstlane_b32 s71, v145
  s_cmp_ge_u32 s71, 3
  s_cbranch_scc1 LDcsq_52
  s_sleep 2
  s_add_u32 s90, s90, 1
  s_cmp_lt_u32 s90, 524288
  s_cbranch_scc1 LWcsq_51
LDcsq_52:
  v_lshrrev_b32 v140, 4, v1
  v_mul_u32_u24 v140, 30720, v140
  v_and_b32 v141, 15, v1
  v_lshl_add_u32 v140, v141, 4, v140
  s_mul_i32 s70, s3, 1280
  s_add_u32 s70, s70, 1063936
  s_add_u32 s71, s70, 5120
  s_sub_u32 s72, s70, 5120
  s_mov_b32 s90, 0
PLcs_53:
  buffer_load_dwordx4 v[100:103], v140, s[64:67], s70 offen offset:0 sc1
  buffer_load_dwordx4 v[104:107], v140, s[64:67], s70 offen offset:256 sc1
  buffer_load_dwordx4 v[108:111], v140, s[64:67], s70 offen offset:512 sc1
  buffer_load_dwordx4 v[112:115], v140, s[64:67], s70 offen offset:768 sc1
  buffer_load_dwordx4 v[116:119], v140, s[64:67], s70 offen offset:1024 sc1
  buffer_load_dwordx4 v[120:123], v140, s[64:67], s71 offen offset:0 sc1
  buffer_load_dwordx4 v[124:127], v140, s[64:67], s71 offen offset:256 sc1
  buffer_load_dwordx4 v[128:131], v140, s[64:67], s71 offen offset:512 sc1
  buffer_load_dwordx4 v[132:135], v140, s[64:67], s71 offen offset:768 sc1
  buffer_load_dwordx4 v[136:139], v140, s[64:67], s71 offen offset:1024 sc1
  s_waitcnt vmcnt(0)
  v_cmp_ne_u32 s[92:93], s7, v101
  v_cmp_ne_u32 vcc, s7, v103
  s_or_b64 s[92:93], s[92:93], vcc
  v_cmp_ne_u32 vcc, s7, v105
  s_or_b64 s[92:93], s[92:93], vcc
  v_cmp_ne_u32 vcc, s7, v107
  s_or_b64 s[92:93], s[92:93], vcc
  v_cmp_ne_u32 vcc, s7, v109
  s_or_b64 s[92:93], s[92:93], vcc
  v_cmp_ne_u32 vcc, s7, v111
  s_or_b64 s[92:93], s[92:93], vcc
  v_cmp_ne_u32 vcc, s7, v113
  s_or_b64 s[92:93], s[92:93], vcc
  v_cmp_ne_u32 vcc, s7, v115
  s_or_b64 s[92:93], s[92:93], vcc
  v_cmp_ne_u32 vcc, s7, v117
  s_or_b64 s[92:93], s[92:93], vcc
  v_cmp_ne_u32 vcc, s7, v119
  s_or_b64 s[92:93], s[92:93], vcc
  v_cmp_ne_u32 vcc, s7, v121
  s_or_b64 s[92:93], s[92:93], vcc
  v_cmp_ne_u32 vcc, s7, v123
  s_or_b64 s[92:93], s[92:93], vcc
  v_cmp_ne_u32 vcc, s7, v125
  s_or_b64 s[92:93], s[92:93], vcc
  v_cmp_ne_u32 vcc, s7, v127
  s_or_b64 s[92:93], s[92:93], vcc
  v_cmp_ne_u32 vcc, s7, v129
  s_or_b64 s[92:93], s[92:93], vcc
  v_cmp_ne_u32 vcc, s7, v131
  s_or_b64 s[92:93], s[92:93], vcc
  v_cmp_ne_u32 vcc, s7, v133
  s_or_b64 s[92:93], s[92:93], vcc
  v_cmp_ne_u32 vcc, s7, v135
  s_or_b64 s[92:93], s[92:93], vcc
  v_cmp_ne_u32 vcc, s7, v137
  s_or_b64 s[92:93], s[92:93], vcc
  v_cmp_ne_u32 vcc, s7, v139
  s_or_b64 s[92:93], s[92:93], vcc
  s_cmp_eq_u64 s[92:93], 0
  s_cbranch_scc1 PDcs_54
  s_sleep 2
  s_add_u32 s90, s90, 1
  s_cmp_lt_u32 s90, 65536
  s_cbranch_scc1 PLcs_53
PDcs_54:
  s_nop 1
  v_permlane32_swap_b32 v100, v102
  v_permlane32_swap_b32 v104, v106
  v_permlane32_swap_b32 v108, v110
  v_permlane32_swap_b32 v112, v114
  v_permlane32_swap_b32 v116, v118
  v_add_f32 v100, v100, v102
  v_add_f32 v104, v104, v106
  v_add_f32 v108, v108, v110
  v_add_f32 v112, v112, v114
  v_add_f32 v116, v116, v118
  v_permlane16_swap_b32 v100, v104
  v_permlane16_swap_b32 v108, v112
  v_add_f32 v100, v100, v104
  v_add_f32 v108, v108, v112
  v_mov_b32 v142, v116
  s_nop 1
  v_permlane16_swap_b32 v142, v116
  v_add_f32 v116, v142, v116
  v_permlane32_swap_b32 v120, v122
  v_permlane32_swap_b32 v124, v126
  v_permlane32_swap_b32 v128, v130
  v_permlane32_swap_b32 v132, v134
  v_permlane32_swap_b32 v136, v138
  v_add_f32 v120, v120, v122
  v_add_f32 v124, v124, v126
  v_add_f32 v128, v128, v130
  v_add_f32 v132, v132, v134
  v_add_f32 v136, v136, v138
  v_permlane16_swap_b32 v120, v124
  v_permlane16_swap_b32 v128, v132
  v_add_f32 v120, v120, v124
  v_add_f32 v128, v128, v132
  v_mov_b32 v142, v136
  s_nop 1
  v_permlane16_swap_b32 v142, v136
  v_add_f32 v136, v142, v136
  v_lshlrev_b32 v141, 1, v141
  v_lshrrev_b32 v142, 5, v1
  v_add_u32 v141, v141, v142
  v_bfe_u32 v142, v1, 4, 1
  v_lshl_add_u32 v142, v142, 5, v141
  s_mul_i32 s70, s3, 640
  v_lshlrev_b32 v141, 2, v141
  v_add_u32 v141, s70, v141
  v_lshlrev_b32 v142, 2, v142
  v_add_u32 v142, s70, v142
  v_cvt_pk_bf16_f32 v100, v100, v100
  v_lshlrev_b32 v100, 16, v100
  v_cvt_pk_bf16_f32 v120, v120, v120
  v_lshlrev_b32 v120, 16, v120
  v_add_f32 v120, 1.0, v120
  v_cvt_pk_bf16_f32 v120, v120, 0
  v_or_b32 v120, v120, v100
  ds_write_b32 v142, v120 offset:7168
  v_cvt_pk_bf16_f32 v108, v108, v108
  v_lshlrev_b32 v108, 16, v108
  v_cvt_pk_bf16_f32 v128, v128, v128
  v_lshlrev_b32 v128, 16, v128
  v_add_f32 v128, 1.0, v128
  v_cvt_pk_bf16_f32 v128, v128, 0
  v_or_b32 v128, v128, v108
  ds_write_b32 v142, v128 offset:7424
  v_cvt_pk_bf16_f32 v116, v116, v116
  v_lshlrev_b32 v116, 16, v116
  v_cvt_pk_bf16_f32 v136, v136, v136
  v_lshlrev_b32 v136, 16, v136
  v_add_f32 v136, 1.0, v136
  v_cvt_pk_bf16_f32 v136, v136, 0
  v_or_b32 v136, v136, v116
  ds_write_b32 v141, v136 offset:7680
  s_waitcnt lgkmcnt(0)
  s_mov_b64 s[88:89], exec
  s_mov_b64 exec, 1
  ds_add_u32 v3, v2 offset:20
  s_mov_b64 exec, s[88:89]
  s_branch L_a_mid2
L_agu2:
L_ch_gx:
L_pad_104:
  s_cbranch_execz L_pad_105
  s_mov_b32 s90, 0
LWcs_55:
  ds_read_b32 v100, v3 offset:20
  s_waitcnt lgkmcnt(0)
  v_readfirstlane_b32 s70, v100
  s_cmp_ge_u32 s70, 8
  s_cbranch_scc1 LDcs_56
  s_sleep 1
  s_add_u32 s90, s90, 1
  s_cmp_lt_u32 s90, 524288
  s_cbranch_scc1 LWcs_55
LDcs_56:
  v_lshlrev_b32 v100, 3, v1
  ds_read_b64 v[40:41], v100 offset:7168
  ds_read_b64 v[42:43], v100 offset:7680
  ds_read_b64 v[44:45], v100 offset:8192
  ds_read_b64 v[46:47], v100 offset:8704
  ds_read_b64 v[48:49], v100 offset:9216
  s_and_b32 s70, s8, 7
  s_mul_i32 s70, s70, 2560
  s_add_u32 s70, s70, 20480
  s_waitcnt lgkmcnt(0)
  v_lshlrev_b32 v50, 16, v40
  v_lshlrev_b32 v51, 16, v41
  v_lshlrev_b32 v52, 16, v42
  v_lshlrev_b32 v53, 16, v43
  v_lshlrev_b32 v54, 16, v44
  v_lshlrev_b32 v55, 16, v45
L_pad_105:
  s_cbranch_execz L_pad_106
  v_lshlrev_b32 v56, 16, v46
  v_lshlrev_b32 v57, 16, v47
  v_lshlrev_b32 v58, 16, v48
  v_lshlrev_b32 v59, 16, v49
  v_and_b32 v60, 0xffff0000, v40
  v_and_b32 v61, 0xffff0000, v41
  v_and_b32 v62, 0xffff0000, v42
  v_and_b32 v63, 0xffff0000, v43
  v_and_b32 v64, 0xffff0000, v44
  v_and_b32 v65, 0xffff0000, v45
  v_and_b32 v66, 0xffff0000, v46
  v_and_b32 v67, 0xffff0000, v47
  v_and_b32 v68, 0xffff0000, v48
  v_and_b32 v69, 0xffff0000, v49
  v_lshlrev_b32 v102, 4, v1
  s_barrier
  s_barrier
  s_mov_b32 s90, 0
PLx_57:
  buffer_load_dwordx2 v[20:21], v100, s[64:67], s70 offen offset:0 sc1
  buffer_load_dwordx2 v[22:23], v100, s[64:67], s70 offen offset:512 sc1
  buffer_load_dwordx2 v[24:25], v100, s[64:67], s70 offen offset:1024 sc1
  buffer_load_dwordx2 v[26:27], v100, s[64:67], s70 offen offset:1536 sc1
  buffer_load_dwordx2 v[28:29], v100, s[64:67], s70 offen offset:2048 sc1
  s_waitcnt vmcnt(0)
  v_cmp_ne_u32 s[92:93], s7, v21
L_pad_106:
  s_cbranch_execz L_pad_107
  v_cmp_ne_u32 vcc, s7, v23
  s_or_b64 s[92:93], s[92:93], vcc
  v_cmp_ne_u32 vcc, s7, v25
  s_or_b64 s[92:93], s[92:93], vcc
  v_cmp_ne_u32 vcc, s7, v27
  s_or_b64 s[92:93], s[92:93], vcc
  v_cmp_ne_u32 vcc, s7, v29
  s_or_b64 s[92:93], s[92:93], vcc
  s_cmp_eq_u64 s[92:93], 0
  s_cbranch_scc1 PDx_58
  s_sleep 1
  s_add_u32 s90, s90, 1
  s_cmp_lt_u32 s90, 65536
  s_cbranch_scc1 PLx_57
PDx_58:
  v_lshlrev_b32 v30, 16, v20
  v_and_b32 v31, 0xffff0000, v20
  v_lshlrev_b32 v32, 16, v22
  v_and_b32 v33, 0xffff0000, v22
  v_lshlrev_b32 v34, 16, v24
  v_and_b32 v35, 0xffff0000, v24
  v_lshlrev_b32 v36, 16, v26
  v_and_b32 v37, 0xffff0000, v26
  v_lshlrev_b32 v38, 16, v28
  v_and_b32 v39, 0xffff0000, v28
  v_add_f32 v70, v30, v31
L_pad_107:
  s_cbranch_execz L_pad_108
  v_add_f32 v101, v32, v33
  v_add_f32 v71, v34, v35
  v_add_f32 v70, v70, v36
  v_add_f32 v101, v101, v37
  v_add_f32 v71, v71, v38
  v_add_f32 v70, v70, v39
  v_add_f32 v101, v101, v71
  v_add_f32 v70, v70, v101
  s_nop 1
  v_add_f32_dpp v70, v70, v70 quad_perm:[1,0,3,2] row_mask:0xf bank_mask:0xf
  s_nop 1
  v_add_f32_dpp v70, v70, v70 quad_perm:[2,3,0,1] row_mask:0xf bank_mask:0xf
  s_nop 1
  v_add_f32_dpp v70, v70, v70 row_half_mirror row_mask:0xf bank_mask:0xf
  s_nop 1
  v_add_f32_dpp v70, v70, v70 row_ror:8 row_mask:0xf bank_mask:0xf
  v_mov_b32 v101, v70
  s_nop 1
  v_permlane16_swap_b32 v101, v70
  v_add_f32 v70, v101, v70
  v_mov_b32 v101, v70
  s_nop 1
  v_permlane32_swap_b32 v101, v70
  v_add_f32 v70, v101, v70
  v_mul_f32 v70, 0x3acccccd, v70
  v_sub_f32 v30, v30, v70
L_pad_108:
  s_cbranch_execz L_pad_109
  v_sub_f32 v31, v31, v70
  v_sub_f32 v32, v32, v70
  v_sub_f32 v33, v33, v70
  v_sub_f32 v34, v34, v70
  v_sub_f32 v35, v35, v70
  v_sub_f32 v36, v36, v70
  v_sub_f32 v37, v37, v70
  v_sub_f32 v38, v38, v70
  v_sub_f32 v39, v39, v70
  v_mul_f32 v71, v30, v30
  v_mul_f32 v101, v31, v31
  v_fmac_f32 v71, v32, v32
  v_fmac_f32 v101, v33, v33
  v_fmac_f32 v71, v34, v34
  v_fmac_f32 v101, v35, v35
  v_fmac_f32 v71, v36, v36
  v_fmac_f32 v101, v37, v37
  v_fmac_f32 v71, v38, v38
  v_fmac_f32 v101, v39, v39
  v_add_f32 v71, v71, v101
  s_nop 1
  v_add_f32_dpp v71, v71, v71 quad_perm:[1,0,3,2] row_mask:0xf bank_mask:0xf
  s_nop 1
  v_add_f32_dpp v71, v71, v71 quad_perm:[2,3,0,1] row_mask:0xf bank_mask:0xf
L_pad_109:
  s_cbranch_execz L_pad_110
  s_nop 0
  v_add_f32_dpp v71, v71, v71 row_half_mirror row_mask:0xf bank_mask:0xf
  s_nop 1
  v_add_f32_dpp v71, v71, v71 row_ror:8 row_mask:0xf bank_mask:0xf
  v_mov_b32 v101, v71
  s_nop 1
  v_permlane16_swap_b32 v101, v71
  v_add_f32 v71, v101, v71
  v_mov_b32 v101, v71
  s_nop 1
  v_permlane32_swap_b32 v101, v71
  v_add_f32 v71, v101, v71
  v_mov_b32 v101, 0x3727c5ac
  v_fmac_f32 v101, 0x3acccccd, v71
  v_rsq_f32 v71, v101
  s_nop 0
  v_mul_f32 v30, v30, v71
  v_mul_f32 v31, v31, v71
  v_mul_f32 v32, v32, v71
  v_mul_f32 v33, v33, v71
  v_mul_f32 v34, v34, v71
  v_mul_f32 v35, v35, v71
  v_mul_f32 v36, v36, v71
  v_mul_f32 v37, v37, v71
  v_mul_f32 v38, v38, v71
  v_mul_f32 v39, v39, v71
L_pad_110:
  s_cbranch_execz L_pad_111
  v_fma_f32 v30, v30, v50, v60
  v_fma_f32 v31, v31, v51, v61
  v_fma_f32 v32, v32, v52, v62
  v_fma_f32 v33, v33, v53, v63
  v_fma_f32 v34, v34, v54, v64
  v_fma_f32 v35, v35, v55, v65
  v_fma_f32 v36, v36, v56, v66
  v_fma_f32 v37, v37, v57, v67
  v_fma_f32 v38, v38, v58, v68
  v_fma_f32 v39, v39, v59, v69
  v_cvt_pk_bf16_f32 v20, v30, 0
  v_cvt_pk_bf16_f32 v22, v31, 0
  v_lshlrev_b32 v21, 16, v20
  v_lshlrev_b32 v23, 16, v22
  ds_write_b128 v102, v[20:23] offset:20480
  v_cvt_pk_bf16_f32 v24, v32, 0
  v_cvt_pk_bf16_f32 v26, v33, 0
  v_lshlrev_b32 v25, 16, v24
  v_lshlrev_b32 v27, 16, v26
  ds_write_b128 v102, v[24:27] offset:21504
  v_cvt_pk_bf16_f32 v20, v34, 0
  v_cvt_pk_bf16_f32 v22, v35, 0
  v_lshlrev_b32 v21, 16, v20
L_pad_111:
  s_cbranch_execz L_pad_112
  v_lshlrev_b32 v23, 16, v22
  ds_write_b128 v102, v[20:23] offset:22528
  v_cvt_pk_bf16_f32 v24, v36, 0
  v_cvt_pk_bf16_f32 v26, v37, 0
  v_lshlrev_b32 v25, 16, v24
  v_lshlrev_b32 v27, 16, v26
  ds_write_b128 v102, v[24:27] offset:23552
  v_cvt_pk_bf16_f32 v20, v38, 0
  v_cvt_pk_bf16_f32 v22, v39, 0
  v_lshlrev_b32 v21, 16, v20
  v_lshlrev_b32 v23, 16, v22
  ds_write_b128 v102, v[20:23] offset:24576
  s_waitcnt lgkmcnt(0)
  s_barrier
L_pad_112:
  s_cbranch_execz L_ch_gx_ret
  s_branch L_a_end
L_exit:
  s_endpgm
.section .rodata,"a"
.p2align 6
.amdhsa_kernel adaLN_cond__sliding_block_cached__glu_gated_bilinear__decode_kernel
  .amdhsa_next_free_vgpr 168
  .amdhsa_next_free_sgpr 100
  .amdhsa_accum_offset 168
  .amdhsa_group_segment_fixed_size 0
  .amdhsa_kernarg_size 112
  .amdhsa_user_sgpr_count 2
  .amdhsa_user_sgpr_kernarg_segment_ptr 1
  .amdhsa_system_sgpr_workgroup_id_x 1
.end_amdhsa_kernel
```
